```python
import torch

def _softmax(x, axis=-1):
    return torch.softmax(x, dim=axis)

def _gelu(x):
    return torch.nn.functional.gelu(x, approximate='tanh')

def _silu(x):
    return torch.nn.functional.silu(x)

def _sigmoid(x):
    return torch.sigmoid(x)

def _layernorm(x, axis=-1, eps=1e-05):
    m = x.mean(dim=axis, keepdim=True)
    v = x.var(dim=axis, keepdim=True, unbiased=False)
    return (x - m) / torch.sqrt(v + eps)

def _scatter_add(tgt, idx, src, axis=0):
    return tgt.clone().index_add_(axis, idx, src)

def _segment_sum(src, seg, n):
    out = torch.zeros((n,) + src.shape[1:], dtype=src.dtype)
    return out.index_add_(0, seg, src)

def _pad(x, pw):
    flat = tuple((v for pair in reversed(pw) for v in pair))
    return torch.nn.functional.pad(x, flat)
kernel_name = 'adaLN_cond__ssm_conv_s4__geglu_ffn__prompt'

def setup_inputs():

    _w = lambda a: (lambda t: t.to(torch.bfloat16) if t.is_floating_point() else t)(torch.as_tensor(a))

    def _A_setup():
        B, L, D, N = (1, 2048, 512, 128)
        A_re = -(lambda _x: torch.exp(torch.as_tensor(_x)))((lambda *s: torch.randn(*s, dtype=torch.bfloat16) * 3.2)(D, N))
        A_im = torch.pi * (lambda *s: torch.randn(*s, dtype=torch.bfloat16) * 0.1)(D, N)
        B_re = (lambda *s: torch.randn(*s, dtype=torch.bfloat16) * 0.2)(D, N)
        B_im = (lambda *s: torch.randn(*s, dtype=torch.bfloat16) * 0.2)(D, N)
        C_re = (lambda *s: torch.randn(*s, dtype=torch.bfloat16) * 0.2)(D, N)
        C_im = (lambda *s: torch.randn(*s, dtype=torch.bfloat16) * 0.2)(D, N)
        log_dt = (lambda *s: torch.randn(*s, dtype=torch.bfloat16) * 0.1)(D) * 0.5 - 4.0
        Dskip = (lambda *s: torch.randn(*s, dtype=torch.bfloat16) * 0.1)(D)
        return {'u': _w((lambda *s: torch.randn(*s, dtype=torch.bfloat16) * 0.05)(B, L, D)), 'A_re': _w(A_re), 'A_im': _w(A_im), 'B_re': _w(B_re), 'B_im': _w(B_im), 'C_re': _w(C_re), 'C_im': _w(C_im), 'log_dt': _w(log_dt), 'Dskip': _w(Dskip)}
    _A_in = _A_setup()

    def _B_setup():
        B, S, D, F = (1, 2048, 512, 1792)
        return {'x': _w((lambda *s: torch.randn(*s, dtype=torch.bfloat16) * 0.05)(B, S, D)), 'w_gate': _w((lambda *s: torch.randn(*s, dtype=torch.bfloat16) * 0.05)(D, F)), 'w_up': _w((lambda *s: torch.randn(*s, dtype=torch.bfloat16) * 0.05)(D, F)), 'w_down': _w((lambda *s: torch.randn(*s, dtype=torch.bfloat16) * 0.05)(F, D))}
    _B_in = _B_setup()
    return {'A_u': _A_in['u'], 'A_A_re': _A_in['A_re'], 'A_A_im': _A_in['A_im'], 'A_B_re': _A_in['B_re'], 'A_B_im': _A_in['B_im'], 'A_C_re': _A_in['C_re'], 'A_C_im': _A_in['C_im'], 'A_log_dt': _A_in['log_dt'], 'A_Dskip': _A_in['Dskip'], 'B_x': _B_in['x'], 'B_w_gate': _B_in['w_gate'], 'B_w_up': _B_in['w_up'], 'B_w_down': _B_in['w_down'], 'c': _w((lambda *s: torch.randn(*s, dtype=torch.bfloat16) * 0.1)(1, 512) * 8.0), 'w_mod': _w((lambda *s: torch.randn(*s, dtype=torch.bfloat16) * 0.1)(512, 6 * 512) * 512 ** (-0.5) * 8.0)}

def reference(A_u, A_A_re, A_A_im, A_B_re, A_B_im, A_C_re, A_C_im, A_log_dt, A_Dskip, B_x, B_w_gate, B_w_up, B_w_down, c, w_mod):

    def _A_ref(u, A_re, A_im, B_re, B_im, C_re, C_im, log_dt, Dskip):
        Bsz, L, D = u.shape
        dt = torch.exp(log_dt)[:, None]
        A = A_re + 1j * A_im
        Bc = B_re + 1j * B_im
        Cc = C_re + 1j * C_im
        logdA = dt * A
        dB = dt * Bc
        l = (lambda x, dt: x.to(dt))(torch.arange(L), A_re.dtype)
        P = torch.exp(logdA[:, :, None] * l[None, None, :])
        K = torch.einsum('dn,dnl,dn->dl', Cc, P, dB).real
        L2 = 2 * L
        Kp = _pad(K, ((0, 0), (0, L)))
        up = (lambda x, *d: x.permute(*d))(u, 0, 2, 1)
        up = _pad(up, ((0, 0), (0, 0), (0, L)))
        Kf = (lambda x, axes=(-2, -1): torch.fft.rfft2(x.float(), dim=axes))(Kp[:, None, :], axes=(-2, -1))
        Uf = (lambda x, axes=(-2, -1): torch.fft.rfft2(x.float(), dim=axes))(up[:, :, None, :], axes=(-2, -1))
        Yf = Uf * Kf[None, :, :, :]
        y = (lambda x, s, axes=(-2, -1): torch.fft.irfft2(x, s=s, dim=axes).to(torch.bfloat16))(Yf, (1, L2), axes=(-2, -1))[:, :, 0, :L]
        y = (lambda x, *d: x.permute(*d))(y, 0, 2, 1) + u * Dskip[None, None, :]
        return y

    def _B_ref(x, w_gate, w_up, w_down):
        return _gelu(x @ w_gate) * (x @ w_up) @ w_down
    x = A_u
    mod = (_silu(c) @ w_mod).reshape(c.shape[0], 6, 1, -1)
    sa, ca, ga, sb, cb, gb = (mod[:, 0].clone(), mod[:, 1].clone(), mod[:, 2].clone(), mod[:, 3].clone(), mod[:, 4].clone(), mod[:, 5].clone())
    h = _layernorm(x, axis=-1) * (1 + ca) + sa
    x = x + ga * _A_ref(h, A_A_re, A_A_im, A_B_re, A_B_im, A_C_re, A_C_im, A_log_dt, A_Dskip)
    h = _layernorm(x, axis=-1) * (1 + cb) + sb
    x = x + gb * _B_ref(h, B_w_gate, B_w_up, B_w_down)
    return x
```

```asm
; @launch grid=(256,1,1) block=(256,1,1) lds=163840
.amdgcn_target "amdgcn-amd-amdhsa--gfx950"
.text
.globl adaLN_cond__ssm_conv_s4__geglu_ffn__prompt_kernel
.p2align 8
.type adaLN_cond__ssm_conv_s4__geglu_ffn__prompt_kernel,@function
adaLN_cond__ssm_conv_s4__geglu_ffn__prompt_kernel:
    s_cmp_ge_u32 s2, 256
    s_cbranch_scc1 L_adaLN_cond__ssm_conv_s4__geglu_ffn__prompt_kernel_exit
    s_load_dwordx16 s[8:23], s[0:1], 0
    s_load_dwordx16 s[24:39], s[0:1], 64
    s_load_dwordx4 s[40:43], s[0:1], 128
    s_getpc_b64 s[6:7]
L_pc:
    s_mov_b64 exec, -1
    v_lshrrev_b32 v2, 6, v0
    v_and_b32_e64 v1, 63, v0
    s_lshr_b32 s73, s2, 3
    v_readfirstlane_b32 s75, v2
    s_and_b32 s80, s73, 15
    s_lshl_b32 s80, s80, 11
    v_lshl_add_u32 v3, v1, 5, s80
    s_cmp_lg_u32 s75, 3
    s_cbranch_scc1 L_nopf
    global_load_dword v15, v3, s[6:7]
L_nopf:
    s_and_b32 s72, s2, 7
    s_lshl_b32 s74, s72, 5
    s_add_u32 s74, s74, s73
    s_cmp_eq_u32 s75, 0
    s_cselect_b32 s83, 8, 1
    s_lshl_b32 s82, s83, 10
    s_lshl_b32 s83, s83, 7
    s_and_b32 s84, s74, 7
    s_lshl_b32 s84, s84, 7
    s_lshr_b32 s80, s74, 3
    s_lshl_b32 s80, s80, 16
    s_add_u32 s80, s80, s84
    s_lshl_b32 s81, s74, 13
    s_cmp_eq_u32 s75, 0
    s_cselect_b32 s80, s80, s81
    s_and_b32 s85, s75, 1
    s_sub_u32 s92, 7, s85
    s_lshr_b32 s81, s74, s92
    s_lshl1_add_u32 s81, s85, s81
    s_lshl_b32 s81, s81, 10
    s_add_u32 s84, s84, s81
    s_and_b32 s81, s74, 0xf8
    s_add_u32 s92, s85, 2
    s_lshl_b32 s81, s81, s92
    s_and_b32 s85, s81, 511
    s_mul_i32 s81, s85, 6144
    s_add_u32 s81, s81, s84
    s_mov_b32 s84, 3145728
    s_cmp_lt_u32 s75, 2
    s_cselect_b32 s94, s80, s81
    s_cselect_b32 s82, s82, 6144
    s_cselect_b32 s79, s83, 49152
    s_cselect_b32 s46, 2097152, s84
    s_mov_b32 s47, 0x20000
    v_lshrrev_b32 v3, 3, v1
    v_mul_u32_u24 v3, s82, v3
    v_lshrrev_b32 v4, 2, v1
    v_and_b32 v4, 4, v4
    v_and_b32 v5, 7, v1
    v_xor_b32 v4, v4, v5
    v_lshl_add_u32 v22, v4, 4, v3
    v_xor_b32 v23, 32, v22
    s_lshl_b32 s3, s75, 13
    s_add_u32 s3, s3, 73728
    v_add_u32_e64 v5, s85, v1
    v_and_b32 v5, 511, v5
    v_lshlrev_b32 v5, 1, v5
    s_lshl_b32 s85, s74, 9
    v_lshl_add_u32 v2, v0, 1, s85
    v_mov_b32 v16, 0
    v_mov_b32 v17, 0
    v_mov_b32 v18, 0
    v_mov_b32 v19, 0
    v_mov_b32 v20, 0
    v_mov_b32 v21, 0
    v_mov_b32_e64 v40, 0
    s_lshl_b32 s93, s74, 2
    s_waitcnt lgkmcnt(0)
    global_load_short_d16_hi v16, v2, s[10:11]
    global_load_short_d16_hi v17, v2, s[12:13]
    global_load_short_d16_hi v18, v2, s[14:15]
    global_load_short_d16_hi v19, v2, s[16:17]
    global_load_short_d16_hi v20, v2, s[18:19]
    global_load_short_d16_hi v21, v2, s[20:21]
    s_load_dword s76, s[42:43], 0
    s_load_dword s77, s[22:23], s93
    s_load_dword s78, s[24:25], s93
    s_cmp_lt_u32 s75, 2
    s_cselect_b64 s[44:45], s[8:9], s[36:37]
    s_and_b32 s45, s45, 0xffff
    global_load_short_d16_hi v40, v5, s[34:35]
    s_add_u32 s6, s6, L_table-L_pc+4096
    s_addc_u32 s7, s7, 0
    v_lshlrev_b32 v12, 4, v0
    s_cmp_eq_u32 s75, 3
    s_cbranch_scc1 L_rla
    s_cmp_lg_u32 s75, 1
    s_cbranch_scc1 L_rl0
    buffer_load_dwordx4 v[80:83], v22, s[44:47], s94 offen offset:0
    buffer_load_dwordx4 v[84:87], v22, s[44:47], s94 offen offset:128
    buffer_load_dwordx4 v[88:91], v22, s[44:47], s94 offen offset:256
    buffer_load_dwordx4 v[92:95], v22, s[44:47], s94 offen offset:384
    buffer_load_dwordx4 v[96:99], v22, s[44:47], s94 offen offset:512
    buffer_load_dwordx4 v[100:103], v22, s[44:47], s94 offen offset:640
    buffer_load_dwordx4 v[104:107], v22, s[44:47], s94 offen offset:768
    buffer_load_dwordx4 v[108:111], v22, s[44:47], s94 offen offset:896
    s_branch L_rla
L_rl0:
    s_add_u32 m0, s3, 0
    s_nop 0
    buffer_load_dwordx4 v22, s[44:47], s94 offen  lds
    s_add_u32 m0, s3, 1024
    s_add_u32 s94, s94, s79
    buffer_load_dwordx4 v23, s[44:47], s94 offen  lds
    s_add_u32 m0, s3, 2048
    s_add_u32 s94, s94, s79
    buffer_load_dwordx4 v22, s[44:47], s94 offen  lds
    s_add_u32 m0, s3, 3072
    s_add_u32 s94, s94, s79
    buffer_load_dwordx4 v23, s[44:47], s94 offen  lds
    s_cmp_eq_u32 s75, 2
    s_cbranch_scc1 L_rla
    s_add_u32 m0, s3, 4096
    s_add_u32 s94, s94, s79
    buffer_load_dwordx4 v22, s[44:47], s94 offen  lds
    s_add_u32 m0, s3, 5120
    s_add_u32 s94, s94, s79
    buffer_load_dwordx4 v23, s[44:47], s94 offen  lds
    s_add_u32 m0, s3, 6144
    s_add_u32 s94, s94, s79
    buffer_load_dwordx4 v22, s[44:47], s94 offen  lds
    s_add_u32 m0, s3, 7168
    s_add_u32 s94, s94, s79
    buffer_load_dwordx4 v23, s[44:47], s94 offen  lds
L_rla:
    global_load_dwordx4 v[24:27], v12, s[6:7] offset:-4096
    global_load_dwordx4 v[28:31], v12, s[6:7]
    s_mov_b32 s64, s42
    s_and_b32 s65, s43, 0xffff
    s_mov_b32 s66, 33554432
    s_mov_b32 s67, 0x20000
    s_cmp_lt_u32 s73, 28
    s_cselect_b32 s80, 1835008, 0
    s_cselect_b32 s81, 33554432, 0
    s_mov_b32 s56, s32
    s_and_b32 s57, s33, 0xffff
    s_mov_b32 s58, s80
    s_mov_b32 s59, 0x20000
    s_mov_b32 s68, s42
    s_and_b32 s69, s43, 0xffff
    s_mov_b32 s70, s81
    s_mov_b32 s71, 0x20000
    v_lshlrev_b32 v231, 4, v1
    v_and_b32 v2, 15, v1
    v_and_b32 v3, 48, v1
    v_lshrrev_b32 v4, 4, v1
    v_lshrrev_b32 v5, 5, v1
    v_and_b32 v6, 3, v1
    s_mul_i32 s82, s75, 10240
    s_add_u32 s82, s82, 4096
    v_mul_u32_u24 v7, 320, v4
    v_lshl_add_u32 v7, v2, 4, v7
    v_add_u32 v226, s82, v7
    v_lshrrev_b32 v7, 5, v0
    v_mul_u32_u24 v7, 1280, v7
    v_and_b32_e64 v8, 1, v0
    v_mul_u32_u24 v9, 640, v8
    v_bfe_u32 v10, v0, 1, 4
    v_lshl_add_u32 v9, v10, 4, v9
    v_add_u32 v227, v7, v9
    v_lshrrev_b32 v7, 2, v0
    s_and_b32 s82, s74, 7
    v_xor_b32 v7, s82, v7
    v_lshlrev_b32_e64 v7, 7, v7
    v_lshl_add_u32 v229, v6, 4, v7
    v_mul_u32_u24 v7, 544, v2
    v_add_u32_e64 v7, v7, v3
    v_add_u32 v240, 4096, v7
    v_mul_u32_u24 v7, 80, v2
    s_mul_i32 s82, s75, 1280
    v_add3_u32 v241, v7, v3, s82
    v_bfe_u32 v7, v1, 2, 2
    v_cvt_f32_u32 v244, v5
    v_and_b32 v9, 31, v1
    v_lshlrev_b32 v13, 12, v9
    v_and_b32 v9, 8, v1
    v_lshl_add_u32 v9, v9, 1, v2
    v_lshlrev_b32_e64 v243, 12, v9
    v_lshl_add_u32 v9, v5, 3, v6
    v_bfe_u32 v10, v1, 2, 3
    v_lshlrev_b32 v11, 4, v10
    v_lshl_add_u32 v14, v9, 12, v11
    s_lshl_b32 s82, s75, 6
    s_add_u32 s82, s82, 133120
    v_lshl_add_u32 v10, v10, 3, s82
    v_lshlrev_b32 v11, 8, v5
    v_sub_u32 v242, v10, v11
    v_lshlrev_b32_e64 v10, 5, v5
    v_add_u32 v230, 132864, v10
    v_and_b32_e64 v9, 1, v4
    v_lshl_add_u32 v10, v9, 1, v5
    v_lshl_add_u32 v10, v10, 3, v7
    v_lshl_add_u32 v10, v10, 1, v9
    v_bfe_u32 v11, v1, 3, 1
    v_lshl_add_u32 v10, v10, 1, v11
    v_xor_b32_e64 v10, s75, v10
    v_lshl_add_u32 v10, v10, 1, v8
    v_bfe_u32 v11, v1, 1, 1
    v_lshl_add_u32 v10, v10, 1, v11
    v_lshlrev_b32_e64 v10, 3, v10
    v_add_u32 v228, 116224, v10
    v_mul_u32_u24 v7, 4608, v5
    v_and_b32 v9, 31, v1
    v_min_u32 v9, 29, v9
    v_lshl_add_u32 v7, v9, 4, v7
    v_add_u32 v7, 107008, v7
    v_cmp_gt_u32_e64 vcc, 64, v0
    v_mov_b32 v9, 3840
    v_mov_b32 v120, 0
    v_cndmask_b32 v7, v9, v7, vcc
    v_mov_b32 v121, 0
    v_mov_b32 v122, 0
    v_mov_b32_e64 v123, 0
    ds_write_b128 v7, v[120:123]
    v_lshrrev_b32 v2, 3, v1
    v_and_b32 v3, 2, v2
    v_mul_u32_u24 v2, 3584, v2
    v_and_b32 v4, 7, v1
    v_xor_b32 v3, v3, v4
    v_xor_b32_e64 v4, 4, v3
    v_lshl_add_u32 v34, v3, 4, v2
    v_lshl_add_u32 v35, v4, 4, v2
    v_and_b32_e64 v8, 1, v1
    v_bfe_u32 v7, v1, 1, 3
    v_mul_u32_u24 v7, 4160, v7
    v_lshl_add_u32 v7, v8, 4, v7
    v_add_u32 v33, 77824, v7
    v_lshrrev_b32 v2, 2, v1
    v_and_b32 v5, 3, v1
    v_lshlrev_b32_e64 v5, 4, v5
    v_lshl_add_u32 v36, v2, 10, v5
    v_lshrrev_b32 v6, 5, v1
    v_and_b32 v7, 3, v2
    v_lshl_add_u32 v6, v6, 3, v7
    v_bfe_u32 v7, v1, 4, 1
    v_lshl_add_u32 v6, v6, 1, v7
    v_lshl_add_u32 v6, v6, 1, v8
    v_bfe_u32 v7, v1, 1, 1
    v_lshl_add_u32 v6, v6, 1, v7
    v_lshlrev_b32_e64 v6, 3, v6
    v_add_u32 v32, 133632, v6
    s_mul_i32 s97, s72, 28
    s_add_u32 s97, s97, s73
    s_lshr_b32 s82, s97, 1
    s_lshl_b32 s82, s82, 14
    s_and_b32 s81, s97, 1
    s_lshl_b32 s81, s81, 9
    s_add_u32 s91, s82, s81
    v_min_u32 v246, 27, v1
    v_lshlrev_b32 v246, 6, v246
    s_cmp_eq_u32 s75, 3
    s_cbranch_scc0 L_rlb
    s_add_u32 m0, s3, 0
    s_nop 0
    buffer_load_dwordx4 v22, s[44:47], s94 offen  lds
    s_add_u32 m0, s3, 1024
    s_add_u32 s94, s94, s79
    buffer_load_dwordx4 v23, s[44:47], s94 offen  lds
    s_add_u32 m0, s3, 2048
    s_add_u32 s94, s94, s79
    buffer_load_dwordx4 v22, s[44:47], s94 offen  lds
    s_add_u32 m0, s3, 3072
    s_add_u32 s94, s94, s79
    buffer_load_dwordx4 v23, s[44:47], s94 offen  lds
    s_add_u32 m0, s3, 4096
    s_add_u32 s94, s94, s79
    buffer_load_dwordx4 v22, s[44:47], s94 offen  lds
    s_add_u32 m0, s3, 5120
    s_add_u32 s94, s94, s79
    buffer_load_dwordx4 v23, s[44:47], s94 offen  lds
    s_add_u32 m0, s3, 6144
    s_add_u32 s94, s94, s79
    buffer_load_dwordx4 v22, s[44:47], s94 offen  lds
    s_add_u32 m0, s3, 7168
    s_add_u32 s94, s94, s79
    buffer_load_dwordx4 v23, s[44:47], s94 offen  lds
L_rlb:
    s_mul_i32 s82, s75, 8704
    v_add_u32 v156, s82, v240
    v_mov_b32 v208, 0
    v_mov_b32 v209, 0
    v_mov_b32 v210, 0
    v_mov_b32 v211, 0
    v_mov_b32 v212, 0
    v_mov_b32 v213, 0
    v_mov_b32 v214, 0
    v_mov_b32 v215, 0
    s_cmp_lg_u32 s75, 3
    s_cbranch_scc1 L_main
    s_lshl_b32 s40, s74, 6
    s_add_u32 s40, s40, 327680
    s_and_b32 s80, s97, 1
    s_mul_i32 s80, s80, 112
    s_lshr_b32 s41, s97, 1
    s_add_u32 s41, s41, s80
    s_lshl_b32 s41, s41, 6
    s_add_u32 s41, s41, 917504
    s_waitcnt lgkmcnt(0)
    s_or_b32 s76, s76, 0x7f800000
    s_add_u32 s76, s76, 1
    s_or_b32 s76, s76, 0x7f800000
    s_barrier
    v_mov_b32 v248, s76
    v_mov_b32 v249, s76
    v_mov_b32 v250, s76
    s_mov_b64 exec, 0
    s_branch L_touch0
L_touched:
    s_mov_b64 exec, -1
    s_lshl_b32 s80, s74, 9
    s_add_u32 s80, s80, 131072
    v_add_u32 v4, -1, v248
    v_add_u32 v5, -1, v248
    v_add_u32_e64 v6, -1, v248
    v_add_u32 v7, -1, v248
    s_waitcnt vmcnt(8)
    s_mov_b32 exec_hi, 0
    buffer_store_dwordx4 v[4:7], v231, s[64:67], s80 offen sc1
    s_mov_b64 exec, 0xf
    buffer_store_dwordx4 v[4:7], v231, s[64:67], s40 offen sc1
    buffer_store_dwordx4 v[4:7], v231, s[68:71], s41 offen sc1
    s_mov_b64 exec, -1
    s_branch L_xje
L_main:
    s_cmp_eq_u32 s75, 2
    s_cbranch_scc1 L_rj2
    s_cmp_eq_u32 s75, 1
    s_cbranch_scc1 L_rj1
    v_and_b32 v2, 7, v1
    v_lshrrev_b32 v3, 3, v1
    v_and_b32 v4, 2, v2
    v_lshlrev_b32 v4, 1, v4
    v_xor_b32 v4, v4, v3
    v_lshlrev_b32 v4, 4, v4
    v_lshl_add_u32 v4, v2, 7, v4
    v_add_u32 v4, 73728, v4
    v_xor_b32_e64 v5, 32, v4
    v_mul_u32_u24 v3, 49152, v3
    v_lshl_add_u32 v2, v2, 4, v3
    s_and_b32 s80, s74, 7
    s_mul_i32 s80, s80, 393216
    s_and_b32 s81, s74, 0xf8
    s_lshl4_add_u32 s80, s81, s80
    s_add_u32 s80, s80, 1048576
    s_waitcnt lgkmcnt(0)
    s_or_b32 s76, s76, 0x7f800000
    s_add_u32 s76, s76, 1
    s_or_b32 s76, s76, 0x7f800000
    s_barrier
    s_lshl_b32 s82, s78, 16
    s_and_b32 s83, s78, 0xffff0000
    v_writelane_b32 v208, s82, 0
    v_writelane_b32 v212, s83, 0
    v_mov_b32 v75, s76
    v_mov_b32 v79, s76
    v_mov_b32 v83, s76
    v_mov_b32 v87, s76
    v_mov_b32 v91, s76
    v_mov_b32 v95, s76
    v_mov_b32 v99, s76
    v_mov_b32 v103, s76
    v_mov_b32 v107, s76
    v_mov_b32 v111, s76
    v_mov_b32_e64 v115, s76
    v_mov_b32 v119, s76
    s_waitcnt vmcnt(0)
    ds_read_b128 v[40:43], v4 offset:0
    ds_read_b128 v[44:47], v5 offset:1024
    ds_read_b128 v[48:51], v4 offset:2048
    ds_read_b128 v[52:55], v5 offset:3072
    ds_read_b128 v[56:59], v4 offset:4096
    ds_read_b128 v[60:63], v5 offset:5120
    ds_read_b128 v[64:67], v4 offset:6144
    ds_read_b128 v[68:71], v5 offset:7168
    s_waitcnt lgkmcnt(7)
    v_mov_b32 v72, v40
    s_waitcnt lgkmcnt(6)
    v_mov_b32 v73, v44
    s_waitcnt lgkmcnt(5)
    v_mov_b32 v74, v48
    s_add_u32 s81, s80, 0
    buffer_store_dwordx4 v[72:75], v2, s[64:67], s81 offen sc1
    v_mov_b32 v76, v41
    v_mov_b32 v77, v45
    v_mov_b32 v78, v49
    s_add_u32 s81, s80, 12288
    buffer_store_dwordx4 v[76:79], v2, s[64:67], s81 offen sc1
    v_mov_b32 v80, v42
    v_mov_b32 v81, v46
    v_mov_b32_e64 v82, v50
    s_add_u32 s81, s80, 24576
    buffer_store_dwordx4 v[80:83], v2, s[64:67], s81 offen sc1
    v_mov_b32 v84, v43
    v_mov_b32 v85, v47
    v_mov_b32_e64 v86, v51
    s_add_u32 s81, s80, 36864
    buffer_store_dwordx4 v[84:87], v2, s[64:67], s81 offen sc1
    s_waitcnt lgkmcnt(4)
    v_mov_b32 v88, v52
    s_waitcnt lgkmcnt(3)
    v_mov_b32 v89, v56
    s_waitcnt lgkmcnt(2)
    v_mov_b32 v90, v60
    s_add_u32 s81, s80, 4096
    buffer_store_dwordx4 v[88:91], v2, s[64:67], s81 offen sc1
    v_mov_b32 v92, v53
    v_mov_b32 v93, v57
    v_mov_b32_e64 v94, v61
    s_add_u32 s81, s80, 16384
    buffer_store_dwordx4 v[92:95], v2, s[64:67], s81 offen sc1
    v_mov_b32 v96, v54
    v_mov_b32 v97, v58
    v_mov_b32_e64 v98, v62
    s_add_u32 s81, s80, 28672
    buffer_store_dwordx4 v[96:99], v2, s[64:67], s81 offen sc1
    v_mov_b32 v100, v55
    v_mov_b32 v101, v59
    v_mov_b32_e64 v102, v63
    s_add_u32 s81, s80, 40960
    buffer_store_dwordx4 v[100:103], v2, s[64:67], s81 offen sc1
    s_waitcnt lgkmcnt(1)
    v_mov_b32 v104, v64
    s_waitcnt lgkmcnt(0)
    v_mov_b32 v105, v68
    s_add_u32 s81, s80, 8192
    buffer_store_dwordx4 v[104:107], v2, s[64:67], s81 offen sc1
    v_mov_b32 v108, v65
    v_mov_b32 v109, v69
    s_add_u32 s81, s80, 20480
    buffer_store_dwordx4 v[108:111], v2, s[64:67], s81 offen sc1
    v_mov_b32 v112, v66
    v_mov_b32 v113, v70
    s_add_u32 s81, s80, 32768
    buffer_store_dwordx4 v[112:115], v2, s[64:67], s81 offen sc1
    v_mov_b32 v116, v67
    v_mov_b32 v117, v71
    s_add_u32 s81, s80, 45056
    buffer_store_dwordx4 v[116:119], v2, s[64:67], s81 offen sc1
    s_waitcnt vmcnt(12)
    s_branch L_xje
L_rj1:
    v_mov_b32 v2, 0
    v_mov_b32 v3, 0
    v_mov_b32 v4, 0
    v_mov_b32 v5, 0
    s_mov_b32 s81, 0x3f803f80
    v_add_u32 v6, 81920, v231
    v_mul_u32_u24 v8, 96, v1
    v_lshlrev_b32 v9, 12, v1
    s_lshl_b32 s80, s74, 4
    s_add_u32 s80, s80, 65536
    s_waitcnt lgkmcnt(0)
    s_or_b32 s76, s76, 0x7f800000
    s_add_u32 s76, s76, 1
    s_or_b32 s76, s76, 0x7f800000
    s_barrier
    v_mov_b32 v75, s76
    s_waitcnt vmcnt(8)
    v_dot2c_f32_bf16 v2, s81, v80
    v_dot2c_f32_bf16 v4, v80, v80
    v_dot2c_f32_bf16 v3, s81, v81
    v_dot2c_f32_bf16 v5, v81, v81
    v_dot2c_f32_bf16 v2, s81, v82
    v_dot2c_f32_bf16 v4, v82, v82
    v_dot2c_f32_bf16 v3, s81, v83
    v_dot2c_f32_bf16 v5, v83, v83
    v_dot2c_f32_bf16 v2, s81, v84
    v_dot2c_f32_bf16 v4, v84, v84
    v_dot2c_f32_bf16 v3, s81, v85
    v_dot2c_f32_bf16 v5, v85, v85
    v_dot2c_f32_bf16 v2, s81, v86
    v_dot2c_f32_bf16 v4, v86, v86
    v_dot2c_f32_bf16 v3, s81, v87
    v_dot2c_f32_bf16 v5, v87, v87
    s_waitcnt vmcnt(6)
    v_dot2c_f32_bf16 v2, s81, v88
    v_dot2c_f32_bf16 v4, v88, v88
    v_dot2c_f32_bf16 v3, s81, v89
    v_dot2c_f32_bf16 v5, v89, v89
    v_dot2c_f32_bf16 v2, s81, v90
    v_dot2c_f32_bf16 v4, v90, v90
    v_dot2c_f32_bf16 v3, s81, v91
    v_dot2c_f32_bf16 v5, v91, v91
    v_dot2c_f32_bf16 v2, s81, v92
    v_dot2c_f32_bf16 v4, v92, v92
    v_dot2c_f32_bf16 v3, s81, v93
    v_dot2c_f32_bf16 v5, v93, v93
    v_dot2c_f32_bf16 v2, s81, v94
    v_dot2c_f32_bf16 v4, v94, v94
    v_dot2c_f32_bf16 v3, s81, v95
    v_dot2c_f32_bf16 v5, v95, v95
    s_waitcnt vmcnt(4)
    v_dot2c_f32_bf16 v2, s81, v96
    v_dot2c_f32_bf16 v4, v96, v96
    v_dot2c_f32_bf16 v3, s81, v97
    v_dot2c_f32_bf16 v5, v97, v97
    v_dot2c_f32_bf16 v2, s81, v98
    v_dot2c_f32_bf16 v4, v98, v98
    v_dot2c_f32_bf16 v3, s81, v99
    v_dot2c_f32_bf16 v5, v99, v99
    v_dot2c_f32_bf16 v2, s81, v100
    v_dot2c_f32_bf16 v4, v100, v100
    v_dot2c_f32_bf16 v3, s81, v101
    v_dot2c_f32_bf16 v5, v101, v101
    v_dot2c_f32_bf16 v2, s81, v102
    v_dot2c_f32_bf16 v4, v102, v102
    v_dot2c_f32_bf16 v3, s81, v103
    v_dot2c_f32_bf16 v5, v103, v103
    s_waitcnt vmcnt(2)
    v_dot2c_f32_bf16 v2, s81, v104
    v_dot2c_f32_bf16 v4, v104, v104
    v_dot2c_f32_bf16 v3, s81, v105
    v_dot2c_f32_bf16 v5, v105, v105
    v_dot2c_f32_bf16 v2, s81, v106
    v_dot2c_f32_bf16 v4, v106, v106
    v_dot2c_f32_bf16 v3, s81, v107
    v_dot2c_f32_bf16 v5, v107, v107
    v_dot2c_f32_bf16 v2, s81, v108
    v_dot2c_f32_bf16 v4, v108, v108
    v_dot2c_f32_bf16 v3, s81, v109
    v_dot2c_f32_bf16 v5, v109, v109
    v_dot2c_f32_bf16 v2, s81, v110
    v_dot2c_f32_bf16 v4, v110, v110
    v_dot2c_f32_bf16 v3, s81, v111
    v_dot2c_f32_bf16 v5, v111, v111
    s_nop 1
    v_add_f32 v2, v2, v3
    v_add_f32 v4, v4, v5
    s_nop 0
    v_add_f32_dpp v2, v2, v2 quad_perm:[1,0,3,2] row_mask:0xf bank_mask:0xf
    v_add_f32_dpp v4, v4, v4 quad_perm:[1,0,3,2] row_mask:0xf bank_mask:0xf
    s_nop 0
    v_add_f32_dpp v2, v2, v2 quad_perm:[2,3,0,1] row_mask:0xf bank_mask:0xf
    v_add_f32_dpp v4, v4, v4 quad_perm:[2,3,0,1] row_mask:0xf bank_mask:0xf
    s_nop 0
    v_add_f32_dpp v2, v2, v2 row_half_mirror row_mask:0xf bank_mask:0xf
    v_add_f32_dpp v4, v4, v4 row_half_mirror row_mask:0xf bank_mask:0xf
    v_mul_f32 v2, 0x3b000000, v2
    v_mul_f32 v4, 0x3b000000, v4
    v_fma_f32 v4, -v2, v2, v4
    v_max_f32_e64 v4, 0, v4
    v_cvt_pk_bf16_f32 v4, v4, v4
    v_and_b32 v4, 0xffff0000, v4
    v_add_f32 v4, 0x3727c5ac, v4
    v_cvt_pk_bf16_f32 v4, v4, v4
    v_and_b32 v4, 0xffff0000, v4
    v_sqrt_f32 v4, v4
    s_nop 0
    v_cvt_pk_bf16_f32 v2, v2, v4
    ds_bpermute_b32 v72, v8, v2
    ds_bpermute_b32 v73, v8, v2 offset:32
    ds_bpermute_b32 v74, v8, v2 offset:64
    s_waitcnt lgkmcnt(0)
    s_mov_b64 exec, 7
    buffer_store_dwordx4 v[72:75], v9, s[64:67], s80 offen sc1
    s_mov_b64 exec, -1
    s_waitcnt vmcnt(1)
    s_branch L_xje
.p2align 12
L_page:
L_rj2:
    v_lshrrev_b32_e64 v2, 4, v1
    v_bfe_u32 v3, v1, 2, 2
    v_lshl_add_u32 v4, v2, 3, v3
    v_bfe_u32 v3, v1, 3, 1
    v_lshl_add_u32 v4, v4, 1, v3
    v_and_b32_e64 v3, 1, v2
    v_lshl_add_u32 v4, v4, 1, v3
    v_and_b32_e64 v3, 3, v1
    v_lshl_add_u32 v4, v4, 2, v3
    v_lshlrev_b32_e64 v4, 3, v4
    v_add_u32 v8, 90112, v4
    v_xor_b32 v9, 32, v8
    v_xor_b32 v10, 64, v8
    v_xor_b32 v11, 96, v8
    v_bfe_u32 v4, v1, 1, 2
    v_lshl_add_u32 v4, v4, 2, v2
    v_and_b32_e64 v3, 1, v1
    v_lshl_add_u32 v4, v4, 1, v3
    v_lshlrev_b32_e64 v37, 4, v4
    s_mov_b32 s80, 132608
    v_lshl_add_u32 v6, v1, 1, s80
    v_and_b32_e64 v7, 48, v1
    v_add_u32 v7, s80, v7
    s_lshl_b32 s80, s74, 9
    s_add_u32 s99, s80, 524288
    s_mov_b32 s80, 0xaaaaaaaa
    s_mov_b32 s81, 0xaaaaaaaa
    s_mov_b32 s82, 0xcccccccc
    s_mov_b32 s83, 0xcccccccc
    s_mov_b32 s84, 0xf0f0f0f0
    s_mov_b32 s85, 0xf0f0f0f0
    s_waitcnt lgkmcnt(0)
    s_or_b32 s76, s76, 0x7f800000
    s_add_u32 s76, s76, 1
    s_or_b32 s76, s76, 0x7f800000
    s_barrier
    s_waitcnt vmcnt(6)
    v_mul_f32 v4, 0xbfb8aa3b, v40
    v_exp_f32 v4, v4
    s_nop 0
    v_add_f32_e64 v4, 1.0, v4
    v_rcp_f32 v4, v4
    s_nop 0
    v_mul_f32 v2, v40, v4
    v_cvt_pk_bf16_f32 v2, v2, v2
    ds_write_b16 v6, v2
    ds_read_b128 v[40:43], v7 offset:0
    s_waitcnt vmcnt(0)
    ds_read_b64_tr_b16 v[56:57], v8 offset:0
    ds_read_b64_tr_b16 v[58:59], v8 offset:512
    ds_read_b64_tr_b16 v[60:61], v9 offset:0
    ds_read_b64_tr_b16 v[62:63], v9 offset:512
    ds_read_b64_tr_b16 v[64:65], v10 offset:0
    ds_read_b64_tr_b16 v[66:67], v10 offset:512
    ds_read_b64_tr_b16 v[68:69], v11 offset:0
    ds_read_b64_tr_b16 v[70:71], v11 offset:512
    s_waitcnt lgkmcnt(6)
    v_mfma_f32_16x16x32_bf16 v[88:91], v[56:59], v[40:43], 0
    s_waitcnt lgkmcnt(4)
    v_mfma_f32_16x16x32_bf16 v[92:95], v[60:63], v[40:43], 0
    s_waitcnt lgkmcnt(2)
    v_mfma_f32_16x16x32_bf16 v[96:99], v[64:67], v[40:43], 0
    s_waitcnt lgkmcnt(0)
    v_mfma_f32_16x16x32_bf16 v[100:103], v[68:71], v[40:43], 0
    v_mov_b32 v43, s76
    s_nop 0
    v_cndmask_b32 v56, v88, v90, s[80:81]
    v_cndmask_b32 v57, v89, v91, s[80:81]
    v_cndmask_b32 v58, v92, v94, s[80:81]
    v_cndmask_b32 v59, v93, v95, s[80:81]
    v_cndmask_b32 v60, v96, v98, s[80:81]
    v_cndmask_b32 v61, v97, v99, s[80:81]
    v_cndmask_b32 v62, v100, v102, s[80:81]
    v_cndmask_b32 v63, v101, v103, s[80:81]
    v_cndmask_b32 v64, v56, v58, s[82:83]
    v_cndmask_b32 v65, v57, v59, s[82:83]
    v_cndmask_b32 v66, v60, v62, s[82:83]
    v_cndmask_b32 v67, v61, v63, s[82:83]
    v_cndmask_b32 v40, v64, v66, s[84:85]
    v_cndmask_b32 v41, v65, v67, s[84:85]
    s_mov_b32 exec_lo, 0x00ff00ff
    s_mov_b32 exec_hi, 0x00ff00ff
    buffer_store_dwordx4 v[40:43], v37, s[64:67], s99 offen sc1
    s_mov_b64 exec, -1
    s_waitcnt vmcnt(1)
L_xje:
    v_mov_b32 v251, s76
    s_lshl_b32 s80, s75, 11
    s_lshl_b32 s81, s75, 7
    s_add_u32 m0, s80, 133632
    s_add_u32 s81, s81, s91
    buffer_load_dwordx4 v36, s[56:59], s81 offen  lds
    s_add_u32 m0, s80, 134592
    v_add_u32_e64 v245, s80, v32
    buffer_load_dwordx4 v36, s[56:59], s81 offen offset:64  lds
    s_lshr_b32 s80, s75, 1
    s_mul_i32 s81, s80, 34304
    s_lshl_b32 s82, s75, 8
    s_add_u32 m0, s81, s82
    s_lshl_b32 s80, s80, 4
    s_lshr_b32 s81, s77, s80
    s_lshl_b32 s81, s81, 16
    v_mov_b32 v154, 0x3fb8aa3b
    v_mul_f32 v154, s81, v154
    v_exp_f32 v154, v154
    v_pk_mul_f32 v[128:129], v[20:21], v[18:19] op_sel_hi:[0,1]
    v_pk_fma_f32 v[136:137], v[20:21], v[18:19], v[128:129] op_sel:[1,1,0] op_sel_hi:[1,0,1] neg_lo:[1,0,0]
    v_cvt_pk_bf16_f32 v154, v154, v154
    v_and_b32 v154, 0xffff0000, v154
    v_mul_f32 v152, v154, v16
    v_mul_f32 v153, v154, v17
    v_mul_f32 v152, 0x3fb8aa3b, v152
    v_mul_f32_e64 v153, 0.15915494, v153
    v_pk_mul_f32 v[136:137], v[136:137], v[154:155] op_sel_hi:[1,0] neg_hi:[1,0]
    v_exp_f32 v2, v152
    v_fract_f32 v8, v153
    v_cos_f32 v120, v8
    v_sin_f32 v121, v8
    v_mul_f32 v4, 0x41000000, v152
    v_mul_f32 v9, 0x41000000, v153
    v_exp_f32 v4, v4
    v_fract_f32 v9, v9
    v_cos_f32 v122, v9
    v_sin_f32 v123, v9
    v_mul_f32 v6, 0x43000000, v152
    v_mul_f32 v10, 0x43000000, v153
    v_exp_f32 v6, v6
    v_fract_f32 v10, v10
    v_cos_f32 v124, v10
    v_sin_f32 v125, v10
    v_pk_mul_f32 v[120:121], v[120:121], v[2:3] op_sel_hi:[1,0] neg_hi:[1,0]
    v_pk_mul_f32 v[122:123], v[122:123], v[4:5] op_sel_hi:[1,0]
    v_pk_mul_f32 v[124:125], v[124:125], v[6:7] op_sel_hi:[1,0] neg_hi:[1,0]
    v_mov_b32 v132, 0x3f80
    v_cvt_pk_bf16_f32 v133, v122, v123
    s_mov_b32 s48, s28
    s_and_b32 s49, s29, 0xffff
    ds_write_addtid_b32 v132 offset:30208
    s_mov_b32 s50, s58
    ds_write_addtid_b32 v133 offset:30752
    v_pk_mul_f32 v[128:129], v[122:123], v[122:123] op_sel_hi:[0,1]
    v_pk_fma_f32 v[126:127], v[122:123], v[122:123], v[128:129] op_sel:[1,1,0] op_sel_hi:[1,0,1] neg_lo:[1,0,0]
    v_cvt_pk_bf16_f32 v134, v126, v127
    v_pk_mul_f32 v[130:131], v[126:127], v[122:123] op_sel_hi:[0,1]
    v_pk_fma_f32 v[126:127], v[126:127], v[122:123], v[130:131] op_sel:[1,1,0] op_sel_hi:[1,0,1] neg_lo:[1,0,0]
    v_cvt_pk_bf16_f32 v135, v126, v127
    s_mov_b32 s51, 0x20000
    s_mov_b32 s52, s30
    ds_write_addtid_b32 v134 offset:31296
    s_nop 0
    ds_write_addtid_b32 v135 offset:31840
    v_pk_mul_f32 v[128:129], v[126:127], v[122:123] op_sel_hi:[0,1]
    v_pk_fma_f32 v[126:127], v[126:127], v[122:123], v[128:129] op_sel:[1,1,0] op_sel_hi:[1,0,1] neg_lo:[1,0,0]
    v_cvt_pk_bf16_f32 v132, v126, v127
    v_pk_mul_f32 v[130:131], v[126:127], v[122:123] op_sel_hi:[0,1]
    v_pk_fma_f32 v[126:127], v[126:127], v[122:123], v[130:131] op_sel:[1,1,0] op_sel_hi:[1,0,1] neg_lo:[1,0,0]
    v_cvt_pk_bf16_f32 v133, v126, v127
    s_and_b32 s53, s31, 0xffff
    s_mov_b32 s54, s58
    ds_write_addtid_b32 v132 offset:32384
    s_nop 0
    ds_write_addtid_b32 v133 offset:32928
    v_pk_mul_f32 v[128:129], v[126:127], v[122:123] op_sel_hi:[0,1]
    v_pk_fma_f32 v[126:127], v[126:127], v[122:123], v[128:129] op_sel:[1,1,0] op_sel_hi:[1,0,1] neg_lo:[1,0,0]
    v_cvt_pk_bf16_f32 v134, v126, v127
    v_pk_mul_f32 v[130:131], v[126:127], v[122:123] op_sel_hi:[0,1]
    v_pk_fma_f32 v[126:127], v[126:127], v[122:123], v[130:131] op_sel:[1,1,0] op_sel_hi:[1,0,1] neg_lo:[1,0,0]
    v_cvt_pk_bf16_f32 v135, v126, v127
    s_mov_b32 s55, 0x20000
    s_and_b32 s26, s72, 3
    ds_write_addtid_b32 v134 offset:33472
    s_mul_i32 s26, s26, 7
    ds_write_addtid_b32 v135 offset:34016
    v_pk_mul_f32 v[128:129], v[126:127], v[122:123] op_sel_hi:[0,1]
    v_pk_fma_f32 v[126:127], v[126:127], v[122:123], v[128:129] op_sel:[1,1,0] op_sel_hi:[1,0,1] neg_lo:[1,0,0]
    v_cvt_pk_bf16_f32 v132, v126, v127
    v_pk_mul_f32 v[130:131], v[126:127], v[122:123] op_sel_hi:[0,1]
    v_pk_fma_f32 v[126:127], v[126:127], v[122:123], v[130:131] op_sel:[1,1,0] op_sel_hi:[1,0,1] neg_lo:[1,0,0]
    v_cvt_pk_bf16_f32 v133, v126, v127
    s_lshr_b32 s80, s73, 2
    s_add_u32 s26, s26, s80
    ds_write_addtid_b32 v132 offset:34560
    ds_write_addtid_b32 v133 offset:35104
    v_pk_mul_f32 v[128:129], v[126:127], v[122:123] op_sel_hi:[0,1]
    v_pk_fma_f32 v[126:127], v[126:127], v[122:123], v[128:129] op_sel:[1,1,0] op_sel_hi:[1,0,1] neg_lo:[1,0,0]
    v_cvt_pk_bf16_f32 v134, v126, v127
    v_pk_mul_f32 v[130:131], v[126:127], v[122:123] op_sel_hi:[0,1]
    v_pk_fma_f32 v[126:127], v[126:127], v[122:123], v[130:131] op_sel:[1,1,0] op_sel_hi:[1,0,1] neg_lo:[1,0,0]
    v_cvt_pk_bf16_f32 v135, v126, v127
    s_and_b32 s27, s72, 4
    s_and_b32 s80, s73, 3
    ds_write_addtid_b32 v134 offset:35648
    ds_write_addtid_b32 v135 offset:36192
    v_pk_mul_f32 v[128:129], v[126:127], v[122:123] op_sel_hi:[0,1]
    v_pk_fma_f32 v[126:127], v[126:127], v[122:123], v[128:129] op_sel:[1,1,0] op_sel_hi:[1,0,1] neg_lo:[1,0,0]
    v_cvt_pk_bf16_f32 v132, v126, v127
    v_pk_mul_f32 v[130:131], v[126:127], v[122:123] op_sel_hi:[0,1]
    v_pk_fma_f32 v[126:127], v[126:127], v[122:123], v[130:131] op_sel:[1,1,0] op_sel_hi:[1,0,1] neg_lo:[1,0,0]
    v_cvt_pk_bf16_f32 v133, v126, v127
    s_add_u32 s27, s27, s80
    s_lshl2_add_u32 s80, s26, s75
    ds_write_addtid_b32 v132 offset:36736
    s_mul_i32 s81, s80, 147
    ds_write_addtid_b32 v133 offset:37280
    v_pk_mul_f32 v[128:129], v[126:127], v[122:123] op_sel_hi:[0,1]
    v_pk_fma_f32 v[126:127], v[126:127], v[122:123], v[128:129] op_sel:[1,1,0] op_sel_hi:[1,0,1] neg_lo:[1,0,0]
    v_cvt_pk_bf16_f32 v134, v126, v127
    v_pk_mul_f32 v[130:131], v[126:127], v[122:123] op_sel_hi:[0,1]
    v_pk_fma_f32 v[126:127], v[126:127], v[122:123], v[130:131] op_sel:[1,1,0] op_sel_hi:[1,0,1] neg_lo:[1,0,0]
    v_cvt_pk_bf16_f32 v135, v126, v127
    s_lshr_b32 s81, s81, 10
    s_mul_i32 s82, s81, 7
    ds_write_addtid_b32 v134 offset:37824
    ds_write_addtid_b32 v135 offset:38368
    v_cvt_pk_bf16_f32 v132, v136, v137
    v_pk_mul_f32 v[130:131], v[136:137], v[120:121] op_sel_hi:[0,1]
    v_pk_fma_f32 v[138:139], v[136:137], v[120:121], v[130:131] op_sel:[1,1,0] op_sel_hi:[1,0,1] neg_lo:[1,0,0]
    v_cvt_pk_bf16_f32 v133, v138, v139
    s_sub_u32 s80, s80, s82
    s_mul_i32 s81, s81, 231
    ds_write_addtid_b32 v132 offset:4096
    s_cmp_lt_u32 s80, 2
    ds_write_addtid_b32 v133 offset:4640
    v_pk_mul_f32 v[128:129], v[138:139], v[120:121] op_sel_hi:[0,1]
    v_pk_fma_f32 v[140:141], v[138:139], v[120:121], v[128:129] op_sel:[1,1,0] op_sel_hi:[1,0,1] neg_lo:[1,0,0]
    v_cvt_pk_bf16_f32 v134, v140, v141
    v_pk_mul_f32 v[130:131], v[140:141], v[120:121] op_sel_hi:[0,1]
    v_pk_fma_f32 v[142:143], v[140:141], v[120:121], v[130:131] op_sel:[1,1,0] op_sel_hi:[1,0,1] neg_lo:[1,0,0]
    v_cvt_pk_bf16_f32 v135, v142, v143
    s_cselect_b32 s82, 2, 1
    s_cselect_b32 s83, 1, 33
    ds_write_addtid_b32 v134 offset:5184
    ds_write_addtid_b32 v135 offset:5728
    v_pk_mul_f32 v[128:129], v[142:143], v[120:121] op_sel_hi:[0,1]
    v_pk_fma_f32 v[144:145], v[142:143], v[120:121], v[128:129] op_sel:[1,1,0] op_sel_hi:[1,0,1] neg_lo:[1,0,0]
    v_cvt_pk_bf16_f32 v132, v144, v145
    v_pk_mul_f32 v[130:131], v[144:145], v[120:121] op_sel_hi:[0,1]
    v_pk_fma_f32 v[146:147], v[144:145], v[120:121], v[130:131] op_sel:[1,1,0] op_sel_hi:[1,0,1] neg_lo:[1,0,0]
    v_cvt_pk_bf16_f32 v133, v146, v147
    s_mul_i32 s80, s80, s83
    s_add_u32 s80, s80, s81
    ds_write_addtid_b32 v132 offset:6272
    ds_write_addtid_b32 v133 offset:6816
    v_pk_mul_f32 v[128:129], v[146:147], v[120:121] op_sel_hi:[0,1]
    v_pk_fma_f32 v[148:149], v[146:147], v[120:121], v[128:129] op_sel:[1,1,0] op_sel_hi:[1,0,1] neg_lo:[1,0,0]
    v_cvt_pk_bf16_f32 v134, v148, v149
    v_pk_mul_f32 v[130:131], v[148:149], v[120:121] op_sel_hi:[0,1]
    v_pk_fma_f32 v[150:151], v[148:149], v[120:121], v[130:131] op_sel:[1,1,0] op_sel_hi:[1,0,1] neg_lo:[1,0,0]
    v_cvt_pk_bf16_f32 v135, v150, v151
    s_lshl_b32 s80, s80, 10
    s_add_u32 s80, s80, 6291456
    ds_write_addtid_b32 v134 offset:7360
    s_lshl_b32 s87, s82, 10
    ds_write_addtid_b32 v135 offset:7904
    v_pk_mul_f32 v[128:129], v[136:137], v[124:125] op_sel_hi:[0,1]
    v_pk_fma_f32 v[136:137], v[136:137], v[124:125], v[128:129] op_sel:[1,1,0] op_sel_hi:[1,0,1] neg_lo:[1,0,0]
    v_cvt_pk_bf16_f32 v132, v136, v137
    v_pk_mul_f32 v[130:131], v[138:139], v[124:125] op_sel_hi:[0,1]
    v_pk_fma_f32 v[138:139], v[138:139], v[124:125], v[130:131] op_sel:[1,1,0] op_sel_hi:[1,0,1] neg_lo:[1,0,0]
    v_cvt_pk_bf16_f32 v133, v138, v139
    s_mul_i32 s83, s87, s27
    s_lshl2_add_u32 s86, s83, s80
    ds_write_addtid_b32 v132 offset:8448
    ds_write_addtid_b32 v133 offset:8992
    v_pk_mul_f32 v[128:129], v[140:141], v[124:125] op_sel_hi:[0,1]
    v_pk_fma_f32 v[140:141], v[140:141], v[124:125], v[128:129] op_sel:[1,1,0] op_sel_hi:[1,0,1] neg_lo:[1,0,0]
    v_cvt_pk_bf16_f32 v134, v140, v141
    v_pk_mul_f32 v[130:131], v[142:143], v[124:125] op_sel_hi:[0,1]
    v_pk_fma_f32 v[142:143], v[142:143], v[124:125], v[130:131] op_sel:[1,1,0] op_sel_hi:[1,0,1] neg_lo:[1,0,0]
    v_cvt_pk_bf16_f32 v135, v142, v143
    s_lshl_b32 s82, s82, 15
    s_add_u32 s88, s82, s80
    ds_write_addtid_b32 v134 offset:9536
    ds_write_addtid_b32 v135 offset:10080
    v_pk_mul_f32 v[128:129], v[144:145], v[124:125] op_sel_hi:[0,1]
    v_pk_fma_f32 v[144:145], v[144:145], v[124:125], v[128:129] op_sel:[1,1,0] op_sel_hi:[1,0,1] neg_lo:[1,0,0]
    v_cvt_pk_bf16_f32 v132, v144, v145
    v_pk_mul_f32 v[130:131], v[146:147], v[124:125] op_sel_hi:[0,1]
    v_pk_fma_f32 v[146:147], v[146:147], v[124:125], v[130:131] op_sel:[1,1,0] op_sel_hi:[1,0,1] neg_lo:[1,0,0]
    v_cvt_pk_bf16_f32 v133, v146, v147
    s_lshl_b32 s80, s27, 7
    s_add_u32 s88, s88, s80
    ds_write_addtid_b32 v132 offset:10624
    s_mul_i32 s80, s27, 229376
    ds_write_addtid_b32 v133 offset:11168
    v_pk_mul_f32 v[128:129], v[148:149], v[124:125] op_sel_hi:[0,1]
    v_pk_fma_f32 v[148:149], v[148:149], v[124:125], v[128:129] op_sel:[1,1,0] op_sel_hi:[1,0,1] neg_lo:[1,0,0]
    v_cvt_pk_bf16_f32 v134, v148, v149
    v_pk_mul_f32 v[130:131], v[150:151], v[124:125] op_sel_hi:[0,1]
    v_pk_fma_f32 v[150:151], v[150:151], v[124:125], v[130:131] op_sel:[1,1,0] op_sel_hi:[1,0,1] neg_lo:[1,0,0]
    v_cvt_pk_bf16_f32 v135, v150, v151
    s_lshl_b32 s81, s26, 7
    s_add_u32 s90, s80, s81
    ds_write_addtid_b32 v134 offset:11712
    s_mul_i32 s95, s75, 57344
    ds_write_addtid_b32 v135 offset:12256
    v_pk_mul_f32 v[128:129], v[136:137], v[124:125] op_sel_hi:[0,1]
    v_pk_fma_f32 v[136:137], v[136:137], v[124:125], v[128:129] op_sel:[1,1,0] op_sel_hi:[1,0,1] neg_lo:[1,0,0]
    v_cvt_pk_bf16_f32 v132, v136, v137
    v_pk_mul_f32 v[130:131], v[140:141], v[124:125] op_sel_hi:[0,1]
    v_pk_fma_f32 v[140:141], v[140:141], v[124:125], v[130:131] op_sel:[1,1,0] op_sel_hi:[1,0,1] neg_lo:[1,0,0]
    v_cvt_pk_bf16_f32 v133, v140, v141
    s_add_u32 s95, s95, s90
    s_lshl_b32 s96, s75, 12
    ds_write_addtid_b32 v132 offset:12800
    ds_write_addtid_b32 v133 offset:13344
    v_pk_mul_f32 v[128:129], v[144:145], v[124:125] op_sel_hi:[0,1]
    v_pk_fma_f32 v[144:145], v[144:145], v[124:125], v[128:129] op_sel:[1,1,0] op_sel_hi:[1,0,1] neg_lo:[1,0,0]
    v_cvt_pk_bf16_f32 v134, v144, v145
    v_pk_mul_f32 v[130:131], v[148:149], v[124:125] op_sel_hi:[0,1]
    v_pk_fma_f32 v[148:149], v[148:149], v[124:125], v[130:131] op_sel:[1,1,0] op_sel_hi:[1,0,1] neg_lo:[1,0,0]
    v_cvt_pk_bf16_f32 v135, v148, v149
    s_and_b32 s22, s97, 1
    s_lshl2_add_u32 s22, s22, s75
    ds_write_addtid_b32 v134 offset:13888
    s_mul_i32 s22, s22, 224
    ds_write_addtid_b32 v135 offset:14432
    v_pk_mul_f32 v[128:129], v[136:137], v[124:125] op_sel_hi:[0,1]
    v_pk_fma_f32 v[136:137], v[136:137], v[124:125], v[128:129] op_sel:[1,1,0] op_sel_hi:[1,0,1] neg_lo:[1,0,0]
    v_cvt_pk_bf16_f32 v132, v136, v137
    v_pk_mul_f32 v[130:131], v[140:141], v[124:125] op_sel_hi:[0,1]
    v_pk_fma_f32 v[140:141], v[140:141], v[124:125], v[130:131] op_sel:[1,1,0] op_sel_hi:[1,0,1] neg_lo:[1,0,0]
    v_cvt_pk_bf16_f32 v133, v140, v141
    s_lshr_b32 s23, s97, 1
    s_add_u32 s22, s22, s23
    ds_write_addtid_b32 v132 offset:14976
    ds_write_addtid_b32 v133 offset:15520
    v_pk_mul_f32 v[128:129], v[144:145], v[124:125] op_sel_hi:[0,1]
    v_pk_fma_f32 v[144:145], v[144:145], v[124:125], v[128:129] op_sel:[1,1,0] op_sel_hi:[1,0,1] neg_lo:[1,0,0]
    v_cvt_pk_bf16_f32 v134, v144, v145
    v_pk_mul_f32 v[130:131], v[148:149], v[124:125] op_sel_hi:[0,1]
    v_pk_fma_f32 v[148:149], v[148:149], v[124:125], v[130:131] op_sel:[1,1,0] op_sel_hi:[1,0,1] neg_lo:[1,0,0]
    v_cvt_pk_bf16_f32 v135, v148, v149
    s_lshl_b32 s22, s22, 10
    s_add_u32 s22, s22, 10485760
    ds_write_addtid_b32 v134 offset:16064
    s_nop 0
    ds_write_addtid_b32 v135 offset:16608
    v_pk_mul_f32 v[128:129], v[136:137], v[124:125] op_sel_hi:[0,1]
    v_pk_fma_f32 v[136:137], v[136:137], v[124:125], v[128:129] op_sel:[1,1,0] op_sel_hi:[1,0,1] neg_lo:[1,0,0]
    v_cvt_pk_bf16_f32 v132, v136, v137
    v_pk_mul_f32 v[130:131], v[144:145], v[124:125] op_sel_hi:[0,1]
    v_pk_fma_f32 v[144:145], v[144:145], v[124:125], v[130:131] op_sel:[1,1,0] op_sel_hi:[1,0,1] neg_lo:[1,0,0]
    v_cvt_pk_bf16_f32 v133, v144, v145
    s_add_u32 s23, s22, 114688
    s_mov_b32 s60, s38
    ds_write_addtid_b32 v132 offset:17152
    s_nop 0
    ds_write_addtid_b32 v133 offset:17696
    v_pk_mul_f32 v[128:129], v[136:137], v[124:125] op_sel_hi:[0,1]
    v_pk_fma_f32 v[136:137], v[136:137], v[124:125], v[128:129] op_sel:[1,1,0] op_sel_hi:[1,0,1] neg_lo:[1,0,0]
    v_cvt_pk_bf16_f32 v134, v136, v137
    v_pk_mul_f32 v[130:131], v[144:145], v[124:125] op_sel_hi:[0,1]
    v_pk_fma_f32 v[144:145], v[144:145], v[124:125], v[130:131] op_sel:[1,1,0] op_sel_hi:[1,0,1] neg_lo:[1,0,0]
    v_cvt_pk_bf16_f32 v135, v144, v145
    s_and_b32 s61, s39, 0xffff
    s_mov_b32 s62, 2097152
    ds_write_addtid_b32 v134 offset:18240
    s_mov_b32 s63, 0x20000
    ds_write_addtid_b32 v135 offset:18784
    v_pk_mul_f32 v[128:129], v[136:137], v[124:125] op_sel_hi:[0,1]
    v_pk_fma_f32 v[136:137], v[136:137], v[124:125], v[128:129] op_sel:[1,1,0] op_sel_hi:[1,0,1] neg_lo:[1,0,0]
    v_cvt_pk_bf16_f32 v132, v136, v137
    v_pk_mul_f32 v[130:131], v[144:145], v[124:125] op_sel_hi:[0,1]
    v_pk_fma_f32 v[144:145], v[144:145], v[124:125], v[130:131] op_sel:[1,1,0] op_sel_hi:[1,0,1] neg_lo:[1,0,0]
    v_cvt_pk_bf16_f32 v133, v144, v145
    s_and_b32 s80, s72, 1
    s_lshl2_add_u32 s80, s80, s75
    ds_write_addtid_b32 v132 offset:19328
    s_mul_i32 s80, s80, 1792
    ds_write_addtid_b32 v133 offset:19872
    v_pk_mul_f32 v[128:129], v[136:137], v[124:125] op_sel_hi:[0,1]
    v_pk_fma_f32 v[136:137], v[136:137], v[124:125], v[128:129] op_sel:[1,1,0] op_sel_hi:[1,0,1] neg_lo:[1,0,0]
    v_cvt_pk_bf16_f32 v134, v136, v137
    v_pk_mul_f32 v[130:131], v[144:145], v[124:125] op_sel_hi:[0,1]
    v_pk_fma_f32 v[144:145], v[144:145], v[124:125], v[130:131] op_sel:[1,1,0] op_sel_hi:[1,0,1] neg_lo:[1,0,0]
    v_cvt_pk_bf16_f32 v135, v144, v145
    s_add_u32 s93, s80, 917504
    ds_write_addtid_b32 v134 offset:20416
    ds_write_addtid_b32 v135 offset:20960
    v_pk_mul_f32 v[128:129], v[136:137], v[124:125] op_sel_hi:[0,1]
    v_pk_fma_f32 v[136:137], v[136:137], v[124:125], v[128:129] op_sel:[1,1,0] op_sel_hi:[1,0,1] neg_lo:[1,0,0]
    v_cvt_pk_bf16_f32 v132, v136, v137
    v_pk_mul_f32 v[130:131], v[136:137], v[124:125] op_sel_hi:[0,1]
    v_pk_fma_f32 v[136:137], v[136:137], v[124:125], v[130:131] op_sel:[1,1,0] op_sel_hi:[1,0,1] neg_lo:[1,0,0]
    v_cvt_pk_bf16_f32 v133, v136, v137
    ds_write_addtid_b32 v132 offset:21504
    ds_write_addtid_b32 v133 offset:22048
    v_pk_mul_f32 v[128:129], v[136:137], v[124:125] op_sel_hi:[0,1]
    v_pk_fma_f32 v[136:137], v[136:137], v[124:125], v[128:129] op_sel:[1,1,0] op_sel_hi:[1,0,1] neg_lo:[1,0,0]
    v_cvt_pk_bf16_f32 v134, v136, v137
    v_pk_mul_f32 v[130:131], v[136:137], v[124:125] op_sel_hi:[0,1]
    v_pk_fma_f32 v[136:137], v[136:137], v[124:125], v[130:131] op_sel:[1,1,0] op_sel_hi:[1,0,1] neg_lo:[1,0,0]
    v_cvt_pk_bf16_f32 v135, v136, v137
    ds_write_addtid_b32 v134 offset:22592
    ds_write_addtid_b32 v135 offset:23136
    v_pk_mul_f32 v[128:129], v[136:137], v[124:125] op_sel_hi:[0,1]
    v_pk_fma_f32 v[136:137], v[136:137], v[124:125], v[128:129] op_sel:[1,1,0] op_sel_hi:[1,0,1] neg_lo:[1,0,0]
    v_cvt_pk_bf16_f32 v132, v136, v137
    v_pk_mul_f32 v[130:131], v[136:137], v[124:125] op_sel_hi:[0,1]
    v_pk_fma_f32 v[136:137], v[136:137], v[124:125], v[130:131] op_sel:[1,1,0] op_sel_hi:[1,0,1] neg_lo:[1,0,0]
    v_cvt_pk_bf16_f32 v133, v136, v137
    ds_write_addtid_b32 v132 offset:23680
    ds_write_addtid_b32 v133 offset:24224
    v_pk_mul_f32 v[128:129], v[136:137], v[124:125] op_sel_hi:[0,1]
    v_pk_fma_f32 v[136:137], v[136:137], v[124:125], v[128:129] op_sel:[1,1,0] op_sel_hi:[1,0,1] neg_lo:[1,0,0]
    v_cvt_pk_bf16_f32 v134, v136, v137
    v_pk_mul_f32 v[130:131], v[136:137], v[124:125] op_sel_hi:[0,1]
    v_pk_fma_f32 v[136:137], v[136:137], v[124:125], v[130:131] op_sel:[1,1,0] op_sel_hi:[1,0,1] neg_lo:[1,0,0]
    v_cvt_pk_bf16_f32 v135, v136, v137
    ds_write_addtid_b32 v134 offset:24768
    ds_write_addtid_b32 v135 offset:25312
    v_pk_mul_f32 v[128:129], v[136:137], v[124:125] op_sel_hi:[0,1]
    v_pk_fma_f32 v[136:137], v[136:137], v[124:125], v[128:129] op_sel:[1,1,0] op_sel_hi:[1,0,1] neg_lo:[1,0,0]
    v_cvt_pk_bf16_f32 v132, v136, v137
    ds_write_addtid_b32 v132 offset:25856
    s_add_u32 m0, s96, 116224
    s_nop 0
    buffer_load_dwordx4 v34, s[48:51], s95 offen  lds
    s_add_u32 m0, s96, 118272
    s_nop 0
    buffer_load_dwordx4 v35, s[52:55], s95 offen  lds
    s_add_u32 m0, s96, 117248
    s_add_u32 s95, s95, 28672
    buffer_load_dwordx4 v34, s[48:51], s95 offen  lds
    s_add_u32 m0, s96, 119296
    s_nop 0
    buffer_load_dwordx4 v35, s[52:55], s95 offen  lds
    s_cmp_eq_u32 s75, 3
    s_cbranch_scc1 L_wdjob
    s_waitcnt lgkmcnt(0)
    s_barrier
    ds_read_b128 v[40:43], v240 offset:26112
    ds_read_b128 v[44:47], v156 offset:0
    ds_read_b128 v[48:51], v240 offset:60928
    ds_read_b128 v[52:55], v156 offset:34816
    ds_read_b128 v[56:59], v240 offset:26176
    ds_read_b128 v[60:63], v156 offset:64
    ds_read_b128 v[64:67], v240 offset:60992
    ds_read_b128 v[68:71], v156 offset:34880
    ds_read_b128 v[72:75], v240 offset:26240
    ds_read_b128 v[76:79], v156 offset:128
    ds_read_b128 v[80:83], v240 offset:61056
    ds_read_b128 v[84:87], v156 offset:34944
    ds_read_b128 v[88:91], v240 offset:26304
    ds_read_b128 v[92:95], v156 offset:192
    v_mov_b32 v225, v31
    v_mov_b32_e64 v224, v30
    v_and_b32 v140, 0xffff, v24
    v_lshrrev_b32 v141, 16, v24
    v_and_b32 v142, 0xffff, v25
    s_waitcnt lgkmcnt(12)
    v_mfma_f32_16x16x32_bf16 v[208:211], v[40:43], v[44:47], v[208:211]
    ds_read_b128 v[96:99], v240 offset:61120
    ds_read_b128 v[100:103], v156 offset:35008
    s_waitcnt lgkmcnt(12)
    v_mfma_f32_16x16x32_bf16 v[212:215], v[48:51], v[52:55], v[212:215]
    ds_read_b128 v[104:107], v240 offset:26368
    ds_read_b128 v[108:111], v156 offset:256
    s_waitcnt lgkmcnt(12)
    v_mfma_f32_16x16x32_bf16 v[208:211], v[56:59], v[60:63], v[208:211]
    ds_read_b128 v[40:43], v240 offset:61184
    ds_read_b128 v[44:47], v156 offset:35072
    s_waitcnt lgkmcnt(12)
    v_mfma_f32_16x16x32_bf16 v[212:215], v[64:67], v[68:71], v[212:215]
    ds_read_b128 v[48:51], v240 offset:26432
    ds_read_b128 v[52:55], v156 offset:320
    s_waitcnt lgkmcnt(12)
    v_mfma_f32_16x16x32_bf16 v[208:211], v[72:75], v[76:79], v[208:211]
    ds_read_b128 v[56:59], v240 offset:61248
    ds_read_b128 v[60:63], v156 offset:35136
    s_waitcnt lgkmcnt(12)
    v_mfma_f32_16x16x32_bf16 v[212:215], v[80:83], v[84:87], v[212:215]
    ds_read_b128 v[64:67], v240 offset:26496
    ds_read_b128 v[68:71], v156 offset:384
    s_waitcnt lgkmcnt(12)
    v_mfma_f32_16x16x32_bf16 v[208:211], v[88:91], v[92:95], v[208:211]
    ds_read_b128 v[72:75], v240 offset:61312
    ds_read_b128 v[76:79], v156 offset:35200
    s_waitcnt lgkmcnt(12)
    v_mfma_f32_16x16x32_bf16 v[212:215], v[96:99], v[100:103], v[212:215]
    ds_read_b128 v[80:83], v240 offset:26560
    ds_read_b128 v[84:87], v156 offset:448
    s_waitcnt lgkmcnt(12)
    v_mfma_f32_16x16x32_bf16 v[208:211], v[104:107], v[108:111], v[208:211]
    ds_read_b128 v[88:91], v240 offset:61376
    ds_read_b128 v[92:95], v156 offset:35264
    s_waitcnt lgkmcnt(12)
    v_mfma_f32_16x16x32_bf16 v[212:215], v[40:43], v[44:47], v[212:215]
    s_waitcnt lgkmcnt(10)
    v_mfma_f32_16x16x32_bf16 v[208:211], v[48:51], v[52:55], v[208:211]
    s_waitcnt lgkmcnt(8)
    v_mfma_f32_16x16x32_bf16 v[212:215], v[56:59], v[60:63], v[212:215]
    s_waitcnt lgkmcnt(6)
    v_mfma_f32_16x16x32_bf16 v[208:211], v[64:67], v[68:71], v[208:211]
    s_waitcnt lgkmcnt(4)
    v_mfma_f32_16x16x32_bf16 v[212:215], v[72:75], v[76:79], v[212:215]
    s_waitcnt lgkmcnt(2)
    v_mfma_f32_16x16x32_bf16 v[208:211], v[80:83], v[84:87], v[208:211]
    s_waitcnt lgkmcnt(0)
    v_mfma_f32_16x16x32_bf16 v[212:215], v[88:91], v[92:95], v[212:215]
    v_lshrrev_b32 v143, 16, v25
    v_and_b32 v144, 0xffff, v26
    v_lshrrev_b32_e64 v145, 16, v26
    v_and_b32 v146, 0xffff, v27
    v_lshrrev_b32_e64 v147, 16, v27
    v_and_b32 v148, 0xffff, v28
    v_lshrrev_b32_e64 v149, 16, v28
    v_and_b32 v150, 0xffff, v29
    v_cvt_pk_bf16_f32 v8, v208, v212
    v_cvt_pk_bf16_f32 v9, v209, v213
    v_cvt_pk_bf16_f32 v10, v210, v214
    v_cvt_pk_bf16_f32 v11, v211, v215
    ds_write_b128 v241, v[8:11]
    s_branch L_kgen_end
L_wdjob:
    s_waitcnt lgkmcnt(0)
    s_barrier
    v_mov_b32 v225, v31
    v_mov_b32_e64 v224, v30
    v_and_b32 v140, 0xffff, v24
    v_lshrrev_b32_e64 v141, 16, v24
    v_and_b32 v142, 0xffff, v25
    v_lshrrev_b32_e64 v143, 16, v25
    v_and_b32 v144, 0xffff, v26
    v_lshrrev_b32_e64 v145, 16, v26
    v_and_b32 v146, 0xffff, v27
    v_lshrrev_b32_e64 v147, 16, v27
    v_and_b32 v148, 0xffff, v28
    v_lshrrev_b32_e64 v149, 16, v28
    v_and_b32 v150, 0xffff, v29
    v_lshrrev_b32_e64 v2, 4, v1
    v_bfe_u32 v3, v1, 2, 2
    v_lshl_add_u32 v4, v2, 3, v3
    v_bfe_u32 v3, v1, 3, 1
    v_lshl_add_u32 v4, v4, 1, v3
    v_and_b32_e64 v3, 1, v2
    v_lshl_add_u32 v4, v4, 1, v3
    v_and_b32_e64 v3, 3, v1
    v_lshl_add_u32 v4, v4, 2, v3
    v_lshlrev_b32_e64 v4, 3, v4
    v_add_u32 v8, 98304, v4
    v_xor_b32 v9, 32, v8
    v_xor_b32 v10, 64, v8
    v_xor_b32 v11, 96, v8
    v_bfe_u32 v4, v1, 1, 2
    v_lshl_add_u32 v4, v4, 2, v2
    v_and_b32_e64 v3, 1, v1
    v_lshl_add_u32 v4, v4, 1, v3
    v_lshlrev_b32_e64 v37, 4, v4
    s_mov_b32 s80, 132736
    v_lshl_add_u32 v6, v1, 1, s80
    v_and_b32_e64 v7, 48, v1
    v_add_u32 v7, s80, v7
    s_lshl_b32 s80, s74, 9
    s_add_u32 s99, s80, 655360
    s_mov_b32 s80, 0xaaaaaaaa
    s_mov_b32 s81, 0xaaaaaaaa
    s_mov_b32 s82, 0xcccccccc
    s_mov_b32 s83, 0xcccccccc
    s_mov_b32 s84, 0xf0f0f0f0
    s_mov_b32 s85, 0xf0f0f0f0
    v_mul_f32 v4, 0xbfb8aa3b, v40
    v_exp_f32 v4, v4
    s_nop 0
    v_add_f32_e64 v4, 1.0, v4
    v_rcp_f32 v4, v4
    s_nop 0
    v_mul_f32 v2, v40, v4
    v_cvt_pk_bf16_f32 v2, v2, v2
    ds_write_b16 v6, v2
    ds_read_b128 v[40:43], v7 offset:0
    ds_read_b128 v[44:47], v7 offset:64
    s_waitcnt vmcnt(9)
    ds_read_b64_tr_b16 v[56:57], v8 offset:0
    ds_read_b64_tr_b16 v[58:59], v8 offset:512
    ds_read_b64_tr_b16 v[60:61], v9 offset:0
    ds_read_b64_tr_b16 v[62:63], v9 offset:512
    ds_read_b64_tr_b16 v[64:65], v10 offset:0
    ds_read_b64_tr_b16 v[66:67], v10 offset:512
L_touch0:
    s_cbranch_execz L_touch1
    s_nop 0
    ds_read_b64_tr_b16 v[68:69], v11 offset:0
    ds_read_b64_tr_b16 v[70:71], v11 offset:512
    ds_read_b64_tr_b16 v[72:73], v8 offset:4096
    ds_read_b64_tr_b16 v[74:75], v8 offset:4608
    ds_read_b64_tr_b16 v[76:77], v9 offset:4096
    ds_read_b64_tr_b16 v[78:79], v9 offset:4608
    ds_read_b64_tr_b16 v[80:81], v10 offset:4096
    ds_read_b64_tr_b16 v[82:83], v10 offset:4608
    ds_read_b64_tr_b16 v[84:85], v11 offset:4096
    ds_read_b64_tr_b16 v[86:87], v11 offset:4608
    s_waitcnt lgkmcnt(14)
    v_mfma_f32_16x16x32_bf16 v[88:91], v[56:59], v[40:43], 0
    s_waitcnt lgkmcnt(12)
    v_mfma_f32_16x16x32_bf16 v[92:95], v[60:63], v[40:43], 0
    s_waitcnt lgkmcnt(10)
    v_mfma_f32_16x16x32_bf16 v[96:99], v[64:67], v[40:43], 0
    s_waitcnt lgkmcnt(8)
    v_mfma_f32_16x16x32_bf16 v[100:103], v[68:71], v[40:43], 0
    s_waitcnt lgkmcnt(6)
    v_mfma_f32_16x16x32_bf16 v[88:91], v[72:75], v[44:47], v[88:91]
    s_waitcnt lgkmcnt(4)
    v_mfma_f32_16x16x32_bf16 v[92:95], v[76:79], v[44:47], v[92:95]
    s_waitcnt lgkmcnt(2)
    v_mfma_f32_16x16x32_bf16 v[96:99], v[80:83], v[44:47], v[96:99]
    s_waitcnt lgkmcnt(0)
    v_mfma_f32_16x16x32_bf16 v[100:103], v[84:87], v[44:47], v[100:103]
    v_mov_b32 v43, s76
    s_nop 0
    v_cndmask_b32 v56, v88, v90, s[80:81]
    v_cndmask_b32 v57, v89, v91, s[80:81]
    v_cndmask_b32 v58, v92, v94, s[80:81]
    v_cndmask_b32 v59, v93, v95, s[80:81]
    v_cndmask_b32 v60, v96, v98, s[80:81]
    v_cndmask_b32 v61, v97, v99, s[80:81]
    v_cndmask_b32 v62, v100, v102, s[80:81]
    v_cndmask_b32 v63, v101, v103, s[80:81]
    v_cndmask_b32 v64, v56, v58, s[82:83]
    v_cndmask_b32 v65, v57, v59, s[82:83]
    v_cndmask_b32 v66, v60, v62, s[82:83]
    v_cndmask_b32 v67, v61, v63, s[82:83]
    v_cndmask_b32 v40, v64, v66, s[84:85]
    v_cndmask_b32 v41, v65, v67, s[84:85]
    s_mov_b32 exec_lo, 0x00ff00ff
    s_mov_b32 exec_hi, 0x00ff00ff
    buffer_store_dwordx4 v[40:43], v37, s[64:67], s99 offen sc1
    s_mov_b64 exec, -1
    ds_write_b128 v33, v[208:211]
L_kgen_end:
    s_waitcnt vmcnt(4)
    s_cmp_eq_u32 s75, 0
    s_cbranch_scc1 L_w0a
    s_mul_i32 s94, s74, 12288
    s_add_u32 s94, s94, 1048576
    buffer_load_dwordx4 v[160:163], v12, s[64:67], s94 offen sc1
    s_add_u32 s94, s94, 4096
    buffer_load_dwordx4 v[164:167], v12, s[64:67], s94 offen sc1
    s_add_u32 s94, s94, 4096
    buffer_load_dwordx4 v[168:171], v12, s[64:67], s94 offen sc1
    s_mov_b32 s79, 65536
    buffer_load_dwordx4 v[172:175], v12, s[64:67], s79 offen sc1
    s_mov_b32 s79, 69632
    buffer_load_dwordx4 v[176:179], v12, s[64:67], s79 offen sc1
    s_mov_b32 s79, 73728
    buffer_load_dwordx4 v[180:183], v12, s[64:67], s79 offen sc1
    s_lshl4_add_u32 s3, s74, 524288
    buffer_load_dwordx4 v[184:187], v13, s[64:67], s3 offen sc1
L_w0a:
    s_mov_b32 s84, 0x05040100
    s_mov_b32 s85, 0x07060302
    v_add_u32 v2, 73728, v12
    s_waitcnt lgkmcnt(0)
    s_barrier
    ds_read_b32 v80, v140
    ds_read_b32 v81, v141
    ds_read_b32 v82, v142
    ds_read_b32 v83, v143
    ds_read_b32 v84, v144
    ds_read_b32 v85, v145
    ds_read_b32 v86, v146
    ds_read_b32 v87, v147
    ds_read_b32 v88, v148
    ds_read_b32 v89, v149
    ds_read_b32 v90, v150
    s_waitcnt lgkmcnt(9)
    v_perm_b32 v40, v81, v80, s84
    s_waitcnt lgkmcnt(7)
    v_perm_b32 v41, v83, v82, s84
    s_waitcnt lgkmcnt(5)
    v_perm_b32 v42, v85, v84, s84
    s_waitcnt lgkmcnt(3)
    v_perm_b32 v43, v87, v86, s84
    ds_write_b128 v2, v[40:43] offset:12480
    v_perm_b32 v44, v81, v80, s85
    v_perm_b32 v45, v83, v82, s85
    v_perm_b32 v46, v85, v84, s85
    v_perm_b32 v47, v87, v86, s85
    ds_write_b128 v2, v[44:47] offset:29120
    s_cmp_lg_u32 s75, 0
    s_cbranch_scc1 L_w0b
    s_mul_i32 s94, s74, 12288
    s_add_u32 s94, s94, 1048576
    buffer_load_dwordx4 v[160:163], v12, s[64:67], s94 offen sc1
    s_add_u32 s94, s94, 4096
    buffer_load_dwordx4 v[164:167], v12, s[64:67], s94 offen sc1
    s_add_u32 s94, s94, 4096
    buffer_load_dwordx4 v[168:171], v12, s[64:67], s94 offen sc1
    s_mov_b32 s79, 65536
    buffer_load_dwordx4 v[172:175], v12, s[64:67], s79 offen sc1
    s_mov_b32 s79, 69632
    buffer_load_dwordx4 v[176:179], v12, s[64:67], s79 offen sc1
    s_mov_b32 s79, 73728
    buffer_load_dwordx4 v[180:183], v12, s[64:67], s79 offen sc1
    s_lshl4_add_u32 s3, s74, 524288
    buffer_load_dwordx4 v[184:187], v13, s[64:67], s3 offen sc1
L_w0b:
    v_perm_b32 v48, v82, v81, s84
    v_perm_b32 v49, v84, v83, s84
    v_perm_b32 v50, v86, v85, s84
    s_waitcnt lgkmcnt(4)
    v_perm_b32 v51, v88, v87, s84
    ds_write_b128 v2, v[48:51] offset:8320
    v_perm_b32 v52, v82, v81, s85
    v_perm_b32 v53, v84, v83, s85
    v_perm_b32 v54, v86, v85, s85
    v_perm_b32 v55, v88, v87, s85
    ds_write_b128 v2, v[52:55] offset:24960
    v_perm_b32 v56, v83, v82, s84
    v_perm_b32 v57, v85, v84, s84
    v_perm_b32 v58, v87, v86, s84
    s_waitcnt lgkmcnt(5)
    v_perm_b32 v59, v89, v88, s84
    ds_write_b128 v2, v[56:59] offset:4160
    v_perm_b32 v60, v83, v82, s85
    v_perm_b32 v61, v85, v84, s85
    v_perm_b32 v62, v87, v86, s85
    v_perm_b32 v63, v89, v88, s85
    ds_write_b128 v2, v[60:63] offset:20800
    v_perm_b32 v64, v84, v83, s84
    v_perm_b32 v65, v86, v85, s84
    v_perm_b32 v66, v88, v87, s84
    s_waitcnt lgkmcnt(6)
    v_perm_b32 v67, v90, v89, s84
    ds_write_b128 v2, v[64:67] offset:0
    v_perm_b32 v68, v84, v83, s85
    v_perm_b32 v69, v86, v85, s85
    v_perm_b32 v70, v88, v87, s85
    v_perm_b32 v71, v90, v89, s85
    ds_write_b128 v2, v[68:71] offset:16640
    ds_read_b64_tr_b16 v[216:217], v245 offset:0
    ds_read_b64_tr_b16 v[218:219], v245 offset:256
    ds_read_b64_tr_b16 v[220:221], v245 offset:1024
    ds_read_b64_tr_b16 v[222:223], v245 offset:1280
    s_waitcnt lgkmcnt(2)
    buffer_store_dwordx4 v[216:219], v231, s[68:71], s22 offen sc1
    s_waitcnt lgkmcnt(0)
    buffer_store_dwordx4 v[220:223], v231, s[68:71], s23 offen sc1
    s_waitcnt lgkmcnt(0)
    s_barrier
    ds_read_b64 a[0:1], v224 offset:3776
    ds_read_b64 a[2:3], v224 offset:3784
    ds_read_b64 a[4:5], v224 offset:3264
    ds_read_b64 a[6:7], v224 offset:3272
    ds_read_b64 a[8:9], v224 offset:2752
    ds_read_b64 a[10:11], v224 offset:2760
    ds_read_b64 a[12:13], v224 offset:2240
    ds_read_b64 a[14:15], v224 offset:2248
    ds_read_b64 a[16:17], v224 offset:1728
    ds_read_b64 a[18:19], v224 offset:1736
    ds_read_b64 a[20:21], v224 offset:1216
    ds_read_b64 a[22:23], v224 offset:1224
    ds_read_b64 a[24:25], v224 offset:704
    ds_read_b64 a[26:27], v224 offset:712
    ds_read_b64 a[28:29], v224 offset:192
    ds_read_b64 a[30:31], v224 offset:200
    s_mov_b32 s98, 0
    v_add_u32 v4, 107488, v12
L_ka_chk:
    s_waitcnt vmcnt(2)
    v_add_f32_dpp v184, v184, v184 quad_perm:[1,0,3,2] row_mask:0xf bank_mask:0xf
    v_add_f32_dpp v185, v185, v185 quad_perm:[1,0,3,2] row_mask:0xf bank_mask:0xf
    v_and_b32 v48, 0xffff0000, v172
    v_lshlrev_b32 v40, 16, v172
    v_rcp_f32_e64 v48, v48
    v_add_f32_dpp v184, v184, v184 quad_perm:[2,3,0,1] row_mask:0xf bank_mask:0xf
    v_add_f32_dpp v185, v185, v185 quad_perm:[2,3,0,1] row_mask:0xf bank_mask:0xf
    v_and_b32 v49, 0xffff0000, v173
    v_lshlrev_b32 v41, 16, v173
    v_rcp_f32 v49, v49
    v_add_f32_dpp v184, v184, v184 row_half_mirror row_mask:0xf bank_mask:0xf
    v_add_f32_dpp v185, v185, v185 row_half_mirror row_mask:0xf bank_mask:0xf
    v_and_b32 v50, 0xffff0000, v174
    v_lshlrev_b32 v42, 16, v174
    v_rcp_f32 v50, v50
    v_add_f32_dpp v184, v184, v184 row_mirror row_mask:0xf bank_mask:0xf
    v_add_f32_dpp v185, v185, v185 row_mirror row_mask:0xf bank_mask:0xf
    v_and_b32 v51, 0xffff0000, v176
    v_lshlrev_b32 v43, 16, v176
    v_rcp_f32 v51, v51
    v_cvt_pk_bf16_f32 v184, v184, v185
    v_mov_b32_e64 v185, v184
    v_and_b32 v52, 0xffff0000, v177
    v_lshlrev_b32 v44, 16, v177
    v_rcp_f32 v52, v52
    v_permlane16_swap_b32 v184, v185
    v_lshlrev_b32 v232, 16, v184
    v_and_b32 v233, 0xffff0000, v184
    v_lshlrev_b32_e64 v184, 16, v185
    v_and_b32 v185, 0xffff0000, v185
    v_and_b32 v53, 0xffff0000, v178
    v_lshlrev_b32 v45, 16, v178
    v_rcp_f32 v53, v53
    v_add_f32 v184, 1.0, v184
    v_add_f32 v185, 1.0, v185
    v_cvt_pk_bf16_f32 v184, v184, v185
    v_and_b32 v54, 0xffff0000, v180
    v_lshlrev_b32 v46, 16, v180
    v_rcp_f32 v54, v54
    v_lshlrev_b32_e64 v234, 16, v184
    v_and_b32 v235, 0xffff0000, v184
    v_and_b32 v55, 0xffff0000, v181
    v_lshlrev_b32 v47, 16, v181
    v_rcp_f32 v55, v55
    v_min3_u32 v2, s76, v187, v175
    v_max3_u32 v3, s76, v187, v175
    v_min3_u32 v2, v2, v179, v183
    v_max3_u32 v3, v3, v179, v183
    v_pk_mul_f32 v[64:65], v[48:49], v[234:235] op_sel:[0,0] op_sel_hi:[1,0]
    v_pk_mul_f32 v[66:67], v[50:51], v[234:235] op_sel:[0,0] op_sel_hi:[1,0]
    v_pk_mul_f32 v[68:69], v[52:53], v[234:235] op_sel:[0,0] op_sel_hi:[1,0]
    v_pk_mul_f32 v[70:71], v[54:55], v[234:235] op_sel:[0,0] op_sel_hi:[1,0]
    v_pk_mul_f32 v[72:73], v[48:49], v[234:235] op_sel:[0,1] op_sel_hi:[1,1]
    v_pk_mul_f32 v[74:75], v[50:51], v[234:235] op_sel:[0,1] op_sel_hi:[1,1]
    v_pk_mul_f32 v[76:77], v[52:53], v[234:235] op_sel:[0,1] op_sel_hi:[1,1]
    v_pk_mul_f32 v[78:79], v[54:55], v[234:235] op_sel:[0,1] op_sel_hi:[1,1]
    v_pk_fma_f32 v[80:81], v[40:41], v[64:65], v[232:233] op_sel:[0,0,0] op_sel_hi:[1,1,0] neg_lo:[1,0,0] neg_hi:[1,0,0]
    v_pk_fma_f32 v[82:83], v[42:43], v[66:67], v[232:233] op_sel:[0,0,0] op_sel_hi:[1,1,0] neg_lo:[1,0,0] neg_hi:[1,0,0]
    v_pk_fma_f32 v[84:85], v[44:45], v[68:69], v[232:233] op_sel:[0,0,0] op_sel_hi:[1,1,0] neg_lo:[1,0,0] neg_hi:[1,0,0]
    v_pk_fma_f32 v[86:87], v[46:47], v[70:71], v[232:233] op_sel:[0,0,0] op_sel_hi:[1,1,0] neg_lo:[1,0,0] neg_hi:[1,0,0]
    v_pk_fma_f32 v[88:89], v[40:41], v[72:73], v[232:233] op_sel:[0,0,1] op_sel_hi:[1,1,1] neg_lo:[1,0,0] neg_hi:[1,0,0]
    v_pk_fma_f32 v[90:91], v[42:43], v[74:75], v[232:233] op_sel:[0,0,1] op_sel_hi:[1,1,1] neg_lo:[1,0,0] neg_hi:[1,0,0]
    v_pk_fma_f32 v[92:93], v[44:45], v[76:77], v[232:233] op_sel:[0,0,1] op_sel_hi:[1,1,1] neg_lo:[1,0,0] neg_hi:[1,0,0]
    v_pk_fma_f32 v[94:95], v[46:47], v[78:79], v[232:233] op_sel:[0,0,1] op_sel_hi:[1,1,1] neg_lo:[1,0,0] neg_hi:[1,0,0]
    v_min3_u32 v2, v2, v163, v167
    v_max3_u32 v3, v3, v163, v167
    v_min_u32 v2, v2, v171
    v_max_u32 v3, v3, v171
    v_cmp_ne_u32 vcc, v2, v3
    v_lshlrev_b32 v192, 16, v160
    s_cbranch_vccnz L_ka_retry
L_ka_ok:
    v_lshlrev_b32 v193, 16, v161
    v_lshlrev_b32 v194, 16, v162
    v_lshlrev_b32 v195, 16, v164
    v_lshlrev_b32 v196, 16, v165
    v_lshlrev_b32 v197, 16, v166
    v_lshlrev_b32 v198, 16, v168
    v_lshlrev_b32 v199, 16, v169
    v_pk_fma_f32 v[64:65], v[192:193], v[64:65], v[80:81]
    v_pk_fma_f32 v[66:67], v[194:195], v[66:67], v[82:83]
    v_pk_fma_f32 v[68:69], v[196:197], v[68:69], v[84:85]
    v_pk_fma_f32 v[70:71], v[198:199], v[70:71], v[86:87]
    v_cvt_pk_bf16_f32 v56, v64, v65
    v_cvt_pk_bf16_f32 v57, v66, v67
    v_cvt_pk_bf16_f32 v58, v68, v69
    v_cvt_pk_bf16_f32 v59, v70, v71
    ds_write_b128 v4, v[56:59] offset:0
    v_and_b32 v200, 0xffff0000, v160
    v_and_b32 v201, 0xffff0000, v161
    v_and_b32 v202, 0xffff0000, v162
    v_and_b32 v203, 0xffff0000, v164
    v_and_b32 v204, 0xffff0000, v165
    v_and_b32 v205, 0xffff0000, v166
    v_and_b32 v206, 0xffff0000, v168
    v_and_b32 v207, 0xffff0000, v169
    v_pk_fma_f32 v[72:73], v[200:201], v[72:73], v[88:89]
    v_pk_fma_f32 v[74:75], v[202:203], v[74:75], v[90:91]
    v_pk_fma_f32 v[76:77], v[204:205], v[76:77], v[92:93]
    v_pk_fma_f32 v[78:79], v[206:207], v[78:79], v[94:95]
    v_cvt_pk_bf16_f32 v60, v72, v73
    v_cvt_pk_bf16_f32 v61, v74, v75
    v_cvt_pk_bf16_f32 v62, v76, v77
    v_cvt_pk_bf16_f32 v63, v78, v79
    ds_write_b128 v4, v[60:63] offset:4608
    s_lshl4_add_u32 s3, s74, 655360
    buffer_load_dwordx4 v[144:147], v243, s[64:67], s3 offen sc1
    s_lshl2_add_u32 s3, s27, s75
    s_lshl_b32 s3, s3, 7
    s_add_u32 s3, s3, 688128
    buffer_load_dwordx4 v[148:151], v14, s[64:67], s3 offen sc1
    s_add_u32 s3, s3, 16384
    buffer_load_dwordx4 v[152:155], v14, s[64:67], s3 offen sc1
    s_waitcnt lgkmcnt(0)
    s_barrier
    ds_read_b128 a[64:67], v225 offset:192
    ds_read_b128 a[68:71], v225 offset:704
    ds_read_b128 a[72:75], v225 offset:1216
    ds_read_b128 a[76:79], v225 offset:1728
    ds_read_b128 a[80:83], v225 offset:2240
    ds_read_b128 a[84:87], v225 offset:2752
    ds_read_b128 a[88:91], v225 offset:3264
    ds_read_b128 a[92:95], v225 offset:3776
    s_waitcnt lgkmcnt(7)
    v_mfma_f32_16x16x32_bf16 v[16:19], a[0:3], a[64:67], 0
    ds_read_b128 a[96:99], v225 offset:128
    ds_read_b64 a[32:33], v224 offset:3712
    v_mfma_f32_16x16x32_bf16 v[20:23], a[4:7], a[64:67], 0
    ds_read_b64 a[34:35], v224 offset:3720
    ds_read_b128 a[100:103], v225 offset:640
    v_mfma_f32_16x16x32_bf16 v[24:27], a[8:11], a[64:67], 0
    ds_read_b64 a[36:37], v224 offset:3200
    ds_read_b64_tr_b16 v[160:161], v228 offset:0
    v_mfma_f32_16x16x32_bf16 v[28:31], a[12:15], a[64:67], 0
    ds_read_b64 a[38:39], v224 offset:3208
    ds_read_b64_tr_b16 v[162:163], v228 offset:512
    v_mfma_f32_16x16x32_bf16 v[32:35], a[16:19], a[64:67], 0
    ds_read_b128 a[104:107], v225 offset:1152
    ds_read_b64_tr_b16 v[164:165], v228 offset:4096
    v_mfma_f32_16x16x32_bf16 v[36:39], a[20:23], a[64:67], 0
    ds_read_b64 a[40:41], v224 offset:2688
    ds_read_b64_tr_b16 v[166:167], v228 offset:4608
    v_mfma_f32_16x16x32_bf16 v[40:43], a[24:27], a[64:67], 0
    ds_read_b64 a[42:43], v224 offset:2696
    ds_read_b64_tr_b16 v[168:169], v228 offset:8192
    v_mfma_f32_16x16x32_bf16 v[44:47], a[28:31], a[64:67], 0
    ds_read_b128 a[108:111], v225 offset:1664
    s_waitcnt lgkmcnt(15)
    v_mfma_f32_16x16x32_bf16 v[20:23], a[0:3], a[68:71], v[20:23]
    ds_read_b64 a[44:45], v224 offset:2176
    ds_read_b64_tr_b16 v[170:171], v228 offset:8704
    v_mfma_f32_16x16x32_bf16 v[24:27], a[4:7], a[68:71], v[24:27]
    ds_read_b64 a[46:47], v224 offset:2184
    ds_read_b64_tr_b16 v[172:173], v228 offset:12288
    v_mfma_f32_16x16x32_bf16 v[28:31], a[8:11], a[68:71], v[28:31]
    ds_read_b128 a[112:115], v225 offset:2176
    ds_read_b64_tr_b16 v[174:175], v228 offset:12800
    v_mfma_f32_16x16x32_bf16 v[32:35], a[12:15], a[68:71], v[32:35]
    ds_read_b64 a[48:49], v224 offset:1664
    ds_read_b64 a[50:51], v224 offset:1672
    v_mfma_f32_16x16x32_bf16 v[36:39], a[16:19], a[68:71], v[36:39]
    ds_read_b128 a[116:119], v225 offset:2688
    ds_read_b64 a[52:53], v224 offset:1152
    v_mfma_f32_16x16x32_bf16 v[40:43], a[20:23], a[68:71], v[40:43]
    ds_read_b64 a[54:55], v224 offset:1160
    ds_read_b128 a[120:123], v225 offset:3200
    v_mfma_f32_16x16x32_bf16 v[44:47], a[24:27], a[68:71], v[44:47]
    ds_read_b64 a[56:57], v224 offset:640
    v_mfma_f32_16x16x32_bf16 v[24:27], a[0:3], a[72:75], v[24:27]
    ds_read_b64 a[58:59], v224 offset:648
    ds_read_b128 a[124:127], v225 offset:3712
    v_mfma_f32_16x16x32_bf16 v[28:31], a[4:7], a[72:75], v[28:31]
    ds_read_b64 a[60:61], v224 offset:128
    s_waitcnt lgkmcnt(10)
    v_mfma_f32_16x16x32_bf16 v[32:35], a[8:11], a[72:75], v[32:35]
    ds_read_b64 a[62:63], v224 offset:136
    v_lshlrev_b32 v112, 16, v160
    v_mfma_f32_16x16x32_bf16 v[36:39], a[12:15], a[72:75], v[36:39]
    v_and_b32 v113, 0xffff0000, v160
    v_lshlrev_b32_e64 v114, 16, v161
    v_mfma_f32_16x16x32_bf16 v[40:43], a[16:19], a[72:75], v[40:43]
    v_and_b32 v115, 0xffff0000, v161
    v_lshlrev_b32_e64 v116, 16, v162
    v_mfma_f32_16x16x32_bf16 v[44:47], a[20:23], a[72:75], v[44:47]
    v_and_b32 v117, 0xffff0000, v162
    v_lshlrev_b32_e64 v118, 16, v163
    v_mfma_f32_16x16x32_bf16 v[28:31], a[0:3], a[76:79], v[28:31]
    v_and_b32 v119, 0xffff0000, v163
    v_lshlrev_b32_e64 v120, 16, v164
    v_mfma_f32_16x16x32_bf16 v[32:35], a[4:7], a[76:79], v[32:35]
    v_and_b32 v121, 0xffff0000, v164
    v_lshlrev_b32_e64 v122, 16, v165
    v_mfma_f32_16x16x32_bf16 v[36:39], a[8:11], a[76:79], v[36:39]
    v_and_b32 v123, 0xffff0000, v165
    v_lshlrev_b32_e64 v124, 16, v166
    v_mfma_f32_16x16x32_bf16 v[40:43], a[12:15], a[76:79], v[40:43]
    v_and_b32 v125, 0xffff0000, v166
    v_lshlrev_b32_e64 v126, 16, v167
    v_mfma_f32_16x16x32_bf16 v[44:47], a[16:19], a[76:79], v[44:47]
    v_and_b32 v127, 0xffff0000, v167
    v_lshlrev_b32_e64 v128, 16, v168
    v_mfma_f32_16x16x32_bf16 v[32:35], a[0:3], a[80:83], v[32:35]
    v_and_b32 v129, 0xffff0000, v168
    v_lshlrev_b32_e64 v130, 16, v169
    v_mfma_f32_16x16x32_bf16 v[36:39], a[4:7], a[80:83], v[36:39]
    v_and_b32 v131, 0xffff0000, v169
    v_lshlrev_b32_e64 v132, 16, v170
    v_mfma_f32_16x16x32_bf16 v[40:43], a[8:11], a[80:83], v[40:43]
    v_and_b32 v133, 0xffff0000, v170
    v_lshlrev_b32_e64 v134, 16, v171
    v_mfma_f32_16x16x32_bf16 v[44:47], a[12:15], a[80:83], v[44:47]
    v_and_b32 v135, 0xffff0000, v171
    v_lshlrev_b32_e64 v136, 16, v172
    v_mfma_f32_16x16x32_bf16 v[36:39], a[0:3], a[84:87], v[36:39]
    v_and_b32 v137, 0xffff0000, v172
    v_lshlrev_b32_e64 v138, 16, v173
    v_mfma_f32_16x16x32_bf16 v[40:43], a[4:7], a[84:87], v[40:43]
    v_and_b32 v139, 0xffff0000, v173
    v_lshlrev_b32_e64 v140, 16, v174
    v_mfma_f32_16x16x32_bf16 v[44:47], a[8:11], a[84:87], v[44:47]
    v_and_b32 v141, 0xffff0000, v174
    v_lshlrev_b32 v142, 16, v175
    v_mfma_f32_16x16x32_bf16 v[40:43], a[0:3], a[88:91], v[40:43]
    v_and_b32 v143, 0xffff0000, v175
L_q_chk:
    s_waitcnt vmcnt(0)
    v_min3_u32 v2, v147, v151, v155
    v_max3_u32 v3, v147, v151, v155
    v_min_u32 v2, s76, v2
    v_max_u32 v3, s76, v3
    v_cmp_ne_u32_e64 vcc, v2, v3
    s_nop 0
    s_cbranch_vccnz L_q_retry
L_q_ok:
    v_mfma_f32_16x16x32_bf16 v[44:47], a[4:7], a[88:91], v[44:47]
    v_add_f32_e64 v148, v148, v152
    v_add_f32 v149, v149, v153
    v_mfma_f32_16x16x32_bf16 v[44:47], a[0:3], a[92:95], v[44:47]
    v_add_f32_dpp v144, v144, v144 quad_perm:[1,0,3,2] row_mask:0xf bank_mask:0xf
    s_waitcnt lgkmcnt(0)
    v_mfma_f32_16x16x32_bf16 v[16:19], a[32:35], a[96:99], v[16:19]
    v_add_f32_dpp v145, v145, v145 quad_perm:[1,0,3,2] row_mask:0xf bank_mask:0xf
    v_add_f32_dpp v148, v148, v148 quad_perm:[1,0,3,2] row_mask:0xf bank_mask:0xf
    v_mfma_f32_16x16x32_bf16 v[20:23], a[32:35], a[100:103], v[20:23]
    v_add_f32_dpp v149, v149, v149 quad_perm:[1,0,3,2] row_mask:0xf bank_mask:0xf
    v_add_f32_dpp v144, v144, v144 quad_perm:[2,3,0,1] row_mask:0xf bank_mask:0xf
    v_mfma_f32_16x16x32_bf16 v[20:23], a[36:39], a[96:99], v[20:23]
    v_add_f32_dpp v145, v145, v145 quad_perm:[2,3,0,1] row_mask:0xf bank_mask:0xf
    v_add_f32_dpp v148, v148, v148 quad_perm:[2,3,0,1] row_mask:0xf bank_mask:0xf
    v_mfma_f32_16x16x32_bf16 v[24:27], a[32:35], a[104:107], v[24:27]
    v_add_f32_dpp v149, v149, v149 quad_perm:[2,3,0,1] row_mask:0xf bank_mask:0xf
    v_add_f32_dpp v144, v144, v144 row_half_mirror row_mask:0xf bank_mask:0xf
    v_mfma_f32_16x16x32_bf16 v[24:27], a[36:39], a[100:103], v[24:27]
    v_add_f32_dpp v145, v145, v145 row_half_mirror row_mask:0xf bank_mask:0xf
    v_cvt_pk_bf16_f32 v149, v148, v149
    v_mfma_f32_16x16x32_bf16 v[24:27], a[40:43], a[96:99], v[24:27]
    v_cvt_pk_bf16_f32 v145, v144, v145
    v_lshlrev_b32_e64 v148, 16, v149
    v_mfma_f32_16x16x32_bf16 v[28:31], a[32:35], a[108:111], v[28:31]
    v_and_b32 v149, 0xffff0000, v149
    v_lshlrev_b32_e64 v144, 16, v145
    v_mfma_f32_16x16x32_bf16 v[28:31], a[36:39], a[104:107], v[28:31]
    ds_read_b128 a[64:67], v225 offset:64
    v_and_b32 v145, 0xffff0000, v145
    v_mfma_f32_16x16x32_bf16 v[28:31], a[40:43], a[100:103], v[28:31]
    ds_read_b64 a[0:1], v224 offset:3648
    v_add_f32_e64 v148, v148, v244
    v_mfma_f32_16x16x32_bf16 v[28:31], a[44:47], a[96:99], v[28:31]
    ds_read_b64 a[2:3], v224 offset:3656
    v_add_f32_e64 v149, v149, v244
    v_mfma_f32_16x16x32_bf16 v[32:35], a[32:35], a[112:115], v[32:35]
    ds_read_b128 a[68:71], v225 offset:576
    v_cvt_pk_bf16_f32 v149, v148, v149
    v_mfma_f32_16x16x32_bf16 v[32:35], a[36:39], a[108:111], v[32:35]
    ds_read_b64 a[4:5], v224 offset:3136
    v_lshlrev_b32_e64 v148, 16, v149
    v_mfma_f32_16x16x32_bf16 v[32:35], a[40:43], a[104:107], v[32:35]
    ds_read_b64 a[6:7], v224 offset:3144
    v_and_b32 v149, 0xffff0000, v149
    v_mfma_f32_16x16x32_bf16 v[32:35], a[44:47], a[100:103], v[32:35]
    ds_read_b128 a[72:75], v225 offset:1088
    ds_write_b64 v242, v[148:149]
    v_mfma_f32_16x16x32_bf16 v[32:35], a[48:51], a[96:99], v[32:35]
    ds_read_b64 a[8:9], v224 offset:2624
    s_waitcnt lgkmcnt(0)
    s_barrier
    s_cmp_lg_u32 s75, 3
    s_cbranch_scc1 L_nofd
    s_mov_b64 exec, 0xf
    buffer_store_dwordx4 v[248:251], v231, s[68:71], s41 offen sc1
    s_mov_b64 exec, -1
L_nofd:
    v_mfma_f32_16x16x32_bf16 v[36:39], a[32:35], a[116:119], v[36:39]
    ds_read_b64 a[10:11], v224 offset:2632
    ds_read_b128 v[48:51], v230 offset:0
    v_mfma_f32_16x16x32_bf16 v[36:39], a[36:39], a[112:115], v[36:39]
    ds_read_b128 a[76:79], v225 offset:1600
    ds_read_b128 v[52:55], v230 offset:16
    v_mfma_f32_16x16x32_bf16 v[36:39], a[40:43], a[108:111], v[36:39]
    ds_read_b64 a[12:13], v224 offset:2112
    ds_read_b128 v[64:67], v230 offset:64
    v_mfma_f32_16x16x32_bf16 v[36:39], a[44:47], a[104:107], v[36:39]
    ds_read_b64 a[14:15], v224 offset:2120
    ds_read_b128 v[68:71], v230 offset:80
    v_mfma_f32_16x16x32_bf16 v[36:39], a[48:51], a[100:103], v[36:39]
    ds_read_b128 a[80:83], v225 offset:2112
    ds_read_b128 v[80:83], v230 offset:128
    v_mfma_f32_16x16x32_bf16 v[36:39], a[52:55], a[96:99], v[36:39]
    ds_read_b64 a[16:17], v224 offset:1600
    ds_read_b128 v[84:87], v230 offset:144
    v_mfma_f32_16x16x32_bf16 v[40:43], a[32:35], a[120:123], v[40:43]
    ds_read_b64 a[18:19], v224 offset:1608
    ds_read_b128 v[96:99], v230 offset:192
    v_mfma_f32_16x16x32_bf16 v[40:43], a[36:39], a[116:119], v[40:43]
    ds_read_b128 a[84:87], v225 offset:2624
    ds_read_b128 v[100:103], v230 offset:208
    v_mfma_f32_16x16x32_bf16 v[40:43], a[40:43], a[112:115], v[40:43]
    ds_read_b64 a[20:21], v224 offset:1088
    v_mov_b32_dpp v236, v144 row_newbcast:0 row_mask:0xf bank_mask:0xf
    v_mfma_f32_16x16x32_bf16 v[40:43], a[44:47], a[108:111], v[40:43]
    ds_read_b64 a[22:23], v224 offset:1096
    v_mov_b32_dpp v237, v145 row_newbcast:0 row_mask:0xf bank_mask:0xf
    v_mfma_f32_16x16x32_bf16 v[40:43], a[48:51], a[104:107], v[40:43]
    ds_read_b128 a[88:91], v225 offset:3136
    v_mov_b32_dpp v238, v144 row_newbcast:8 row_mask:0xf bank_mask:0xf
    v_mfma_f32_16x16x32_bf16 v[40:43], a[52:55], a[100:103], v[40:43]
    ds_read_b64 a[24:25], v224 offset:576
    v_mov_b32_dpp v239, v145 row_newbcast:8 row_mask:0xf bank_mask:0xf
    v_mfma_f32_16x16x32_bf16 v[40:43], a[56:59], a[96:99], v[40:43]
    ds_read_b64 a[26:27], v224 offset:584
    ds_read_b128 v[56:59], v230 offset:256
    v_mfma_f32_16x16x32_bf16 v[44:47], a[32:35], a[124:127], v[44:47]
    ds_read_b128 a[92:95], v225 offset:3648
    ds_read_b128 v[60:63], v230 offset:272
    v_mfma_f32_16x16x32_bf16 v[44:47], a[36:39], a[120:123], v[44:47]
    ds_read_b64 a[28:29], v224 offset:64
    ds_read_b128 v[72:75], v230 offset:320
    v_mfma_f32_16x16x32_bf16 v[44:47], a[40:43], a[116:119], v[44:47]
    ds_read_b64 a[30:31], v224 offset:72
    ds_read_b128 v[76:79], v230 offset:336
    v_mfma_f32_16x16x32_bf16 v[44:47], a[44:47], a[112:115], v[44:47]
    s_waitcnt lgkmcnt(12)
    v_mul_f32 v48, v112, v48
    v_mfma_f32_16x16x32_bf16 v[44:47], a[48:51], a[108:111], v[44:47]
    v_mul_f32_e64 v49, v113, v49
    v_cvt_pk_bf16_f32 v176, v48, v49
    v_mfma_f32_16x16x32_bf16 v[44:47], a[52:55], a[104:107], v[44:47]
    v_mul_f32 v50, v114, v50
    v_mul_f32 v51, v115, v51
    v_mfma_f32_16x16x32_bf16 v[44:47], a[56:59], a[100:103], v[44:47]
    v_cvt_pk_bf16_f32 v177, v50, v51
    v_mul_f32_e64 v52, v116, v52
    v_mfma_f32_16x16x32_bf16 v[44:47], a[60:63], a[96:99], v[44:47]
    v_mul_f32 v53, v117, v53
    s_waitcnt lgkmcnt(1)
    v_mfma_f32_16x16x32_bf16 v[16:19], a[0:3], a[64:67], v[16:19]
    ds_read_b128 a[96:99], v225 offset:0
    v_cvt_pk_bf16_f32 v178, v52, v53
    v_mfma_f32_16x16x32_bf16 v[20:23], a[0:3], a[68:71], v[20:23]
    ds_read_b64 a[32:33], v224 offset:3584
    v_mul_f32_e64 v54, v118, v54
    v_mfma_f32_16x16x32_bf16 v[20:23], a[4:7], a[64:67], v[20:23]
    ds_read_b64 a[34:35], v224 offset:3592
    v_mul_f32_e64 v55, v119, v55
    v_mfma_f32_16x16x32_bf16 v[24:27], a[0:3], a[72:75], v[24:27]
    ds_read_b128 a[100:103], v225 offset:512
    v_cvt_pk_bf16_f32 v179, v54, v55
    v_mfma_f32_16x16x32_bf16 v[24:27], a[4:7], a[68:71], v[24:27]
    ds_read_b64 a[36:37], v224 offset:3072
    buffer_store_dwordx4 v[176:179], v231, s[68:71], s86 offen sc1
    v_mfma_f32_16x16x32_bf16 v[24:27], a[8:11], a[64:67], v[24:27]
    ds_read_b64 a[38:39], v224 offset:3080
    s_add_u32 s86, s86, s87
    v_mfma_f32_16x16x32_bf16 v[28:31], a[0:3], a[76:79], v[28:31]
    ds_read_b128 a[104:107], v225 offset:1024
    v_mul_f32 v64, v120, v64
    v_mfma_f32_16x16x32_bf16 v[28:31], a[4:7], a[72:75], v[28:31]
    ds_read_b64 a[40:41], v224 offset:2560
    v_mul_f32_e64 v65, v121, v65
    v_mfma_f32_16x16x32_bf16 v[28:31], a[8:11], a[68:71], v[28:31]
    ds_read_b64 a[42:43], v224 offset:2568
    v_cvt_pk_bf16_f32 v180, v64, v65
    v_mfma_f32_16x16x32_bf16 v[28:31], a[12:15], a[64:67], v[28:31]
    ds_read_b128 a[108:111], v225 offset:1536
    v_mul_f32_e64 v66, v122, v66
    v_mfma_f32_16x16x32_bf16 v[32:35], a[0:3], a[80:83], v[32:35]
    ds_read_b64 a[44:45], v224 offset:2048
L_touch1:
    s_cbranch_execz L_touch2
    s_nop 0
    v_mul_f32_e64 v67, v123, v67
    v_mfma_f32_16x16x32_bf16 v[32:35], a[4:7], a[76:79], v[32:35]
    ds_read_b64 a[46:47], v224 offset:2056
    v_cvt_pk_bf16_f32 v181, v66, v67
    v_mfma_f32_16x16x32_bf16 v[32:35], a[8:11], a[72:75], v[32:35]
    ds_read_b128 a[112:115], v225 offset:2048
    v_mul_f32_e64 v68, v124, v68
    v_mfma_f32_16x16x32_bf16 v[32:35], a[12:15], a[68:71], v[32:35]
    ds_read_b64 a[48:49], v224 offset:1536
    v_mul_f32_e64 v69, v125, v69
    v_mfma_f32_16x16x32_bf16 v[32:35], a[16:19], a[64:67], v[32:35]
    ds_read_b64 a[50:51], v224 offset:1544
    v_cvt_pk_bf16_f32 v182, v68, v69
    v_mfma_f32_16x16x32_bf16 v[36:39], a[0:3], a[84:87], v[36:39]
    ds_read_b128 a[116:119], v225 offset:2560
    v_mul_f32_e64 v70, v126, v70
    v_mfma_f32_16x16x32_bf16 v[36:39], a[4:7], a[80:83], v[36:39]
    ds_read_b64 a[52:53], v224 offset:1024
    v_mul_f32_e64 v71, v127, v71
    v_mfma_f32_16x16x32_bf16 v[36:39], a[8:11], a[76:79], v[36:39]
    ds_read_b64 a[54:55], v224 offset:1032
    v_cvt_pk_bf16_f32 v183, v70, v71
    v_mfma_f32_16x16x32_bf16 v[36:39], a[12:15], a[72:75], v[36:39]
    ds_read_b128 a[120:123], v225 offset:3072
    buffer_store_dwordx4 v[180:183], v231, s[68:71], s86 offen sc1
    v_mfma_f32_16x16x32_bf16 v[36:39], a[16:19], a[68:71], v[36:39]
    ds_read_b64 a[56:57], v224 offset:512
    s_add_u32 s86, s86, s87
    v_mfma_f32_16x16x32_bf16 v[36:39], a[20:23], a[64:67], v[36:39]
    ds_read_b64 a[58:59], v224 offset:520
    v_mul_f32 v80, v128, v80
    v_mfma_f32_16x16x32_bf16 v[40:43], a[0:3], a[88:91], v[40:43]
    ds_read_b128 a[124:127], v225 offset:3584
    v_mul_f32_e64 v81, v129, v81
    v_mfma_f32_16x16x32_bf16 v[40:43], a[4:7], a[84:87], v[40:43]
    ds_read_b64 a[60:61], v224 offset:0
    v_cvt_pk_bf16_f32 v184, v80, v81
    v_mfma_f32_16x16x32_bf16 v[40:43], a[8:11], a[80:83], v[40:43]
    ds_read_b64 a[62:63], v224 offset:8
    v_mul_f32_e64 v82, v130, v82
    v_mfma_f32_16x16x32_bf16 v[40:43], a[12:15], a[76:79], v[40:43]
    v_mul_f32_e64 v83, v131, v83
    v_cvt_pk_bf16_f32 v185, v82, v83
    v_mfma_f32_16x16x32_bf16 v[40:43], a[16:19], a[72:75], v[40:43]
    v_mul_f32 v84, v132, v84
    v_mul_f32 v85, v133, v85
    v_mfma_f32_16x16x32_bf16 v[40:43], a[20:23], a[68:71], v[40:43]
    v_cvt_pk_bf16_f32 v186, v84, v85
    v_mul_f32_e64 v86, v134, v86
    v_mfma_f32_16x16x32_bf16 v[40:43], a[24:27], a[64:67], v[40:43]
    v_mul_f32_e64 v87, v135, v87
    v_cvt_pk_bf16_f32 v187, v86, v87
    v_mfma_f32_16x16x32_bf16 v[44:47], a[0:3], a[92:95], v[44:47]
    buffer_store_dwordx4 v[184:187], v231, s[68:71], s86 offen sc1
    s_add_u32 s86, s86, s87
    v_mfma_f32_16x16x32_bf16 v[44:47], a[4:7], a[88:91], v[44:47]
    v_mul_f32 v96, v136, v96
    v_mul_f32_e64 v97, v137, v97
    v_mfma_f32_16x16x32_bf16 v[44:47], a[8:11], a[84:87], v[44:47]
    v_cvt_pk_bf16_f32 v188, v96, v97
    v_mul_f32_e64 v98, v138, v98
    v_mfma_f32_16x16x32_bf16 v[44:47], a[12:15], a[80:83], v[44:47]
    v_mul_f32_e64 v99, v139, v99
    v_cvt_pk_bf16_f32 v189, v98, v99
    v_mfma_f32_16x16x32_bf16 v[44:47], a[16:19], a[76:79], v[44:47]
    v_mul_f32 v100, v140, v100
    v_mul_f32 v101, v141, v101
    v_mfma_f32_16x16x32_bf16 v[44:47], a[20:23], a[72:75], v[44:47]
    v_cvt_pk_bf16_f32 v190, v100, v101
    v_mul_f32_e64 v102, v142, v102
    v_mfma_f32_16x16x32_bf16 v[44:47], a[24:27], a[68:71], v[44:47]
    v_mul_f32 v103, v143, v103
    v_cvt_pk_bf16_f32 v191, v102, v103
    v_mfma_f32_16x16x32_bf16 v[44:47], a[28:31], a[64:67], v[44:47]
    buffer_store_dwordx4 v[188:191], v231, s[68:71], s86 offen sc1
    s_waitcnt lgkmcnt(0)
    v_mfma_f32_16x16x32_bf16 v[16:19], a[32:35], a[96:99], v[16:19]
    ds_read_b128 v[88:91], v230 offset:384
    ds_read_b128 v[92:95], v230 offset:400
    v_mfma_f32_16x16x32_bf16 v[20:23], a[32:35], a[100:103], v[20:23]
    ds_read_b128 v[104:107], v230 offset:448
    ds_read_b128 v[108:111], v230 offset:464
    v_mfma_f32_16x16x32_bf16 v[20:23], a[36:39], a[96:99], v[20:23]
    s_cmp_lg_u32 s75, 2
    s_cbranch_scc1 L_nogb
    s_lshl3_add_u32 s82, s74, 4096
    s_mov_b64 exec, 1
    buffer_store_dwordx2 v[238:239], v231, s[64:67], s82 offen sc1
    s_mov_b64 exec, -1
L_nogb:
    v_mfma_f32_16x16x32_bf16 v[24:27], a[32:35], a[104:107], v[24:27]
    v_mul_f32 v210, v112, v56
    v_mul_f32 v211, v113, v57
    v_mfma_f32_16x16x32_bf16 v[24:27], a[36:39], a[100:103], v[24:27]
    v_fmac_f32 v210, v114, v58
    v_add_f32 v208, v48, v50
    v_mfma_f32_16x16x32_bf16 v[24:27], a[40:43], a[96:99], v[24:27]
    v_fmac_f32 v211, v115, v59
    v_add_f32 v209, v49, v51
    v_mfma_f32_16x16x32_bf16 v[28:31], a[32:35], a[108:111], v[28:31]
    v_fmac_f32 v210, v116, v60
    v_add_f32 v208, v208, v52
    v_mfma_f32_16x16x32_bf16 v[28:31], a[36:39], a[104:107], v[28:31]
    v_fmac_f32 v211, v117, v61
    v_add_f32 v209, v209, v53
    v_mfma_f32_16x16x32_bf16 v[28:31], a[40:43], a[100:103], v[28:31]
    v_fmac_f32 v210, v118, v62
    v_add_f32 v208, v208, v54
    v_mfma_f32_16x16x32_bf16 v[28:31], a[44:47], a[96:99], v[28:31]
    v_fmac_f32 v211, v119, v63
    v_add_f32 v209, v209, v55
    v_mfma_f32_16x16x32_bf16 v[32:35], a[32:35], a[112:115], v[32:35]
    v_fmac_f32 v210, v120, v72
    v_add_f32 v208, v208, v64
    v_mfma_f32_16x16x32_bf16 v[32:35], a[36:39], a[108:111], v[32:35]
    v_fmac_f32 v211, v121, v73
    v_add_f32 v209, v209, v65
    v_mfma_f32_16x16x32_bf16 v[32:35], a[40:43], a[104:107], v[32:35]
    v_fmac_f32 v210, v122, v74
    v_add_f32 v208, v208, v66
    v_mfma_f32_16x16x32_bf16 v[32:35], a[44:47], a[100:103], v[32:35]
    v_fmac_f32 v211, v123, v75
    v_add_f32 v209, v209, v67
    v_mfma_f32_16x16x32_bf16 v[32:35], a[48:51], a[96:99], v[32:35]
    v_fmac_f32 v210, v124, v76
    v_add_f32 v208, v208, v68
    v_mfma_f32_16x16x32_bf16 v[36:39], a[32:35], a[116:119], v[36:39]
    v_fmac_f32 v211, v125, v77
    v_add_f32 v209, v209, v69
    v_mfma_f32_16x16x32_bf16 v[36:39], a[36:39], a[112:115], v[36:39]
    v_fmac_f32 v210, v126, v78
    v_add_f32 v208, v208, v70
    v_mfma_f32_16x16x32_bf16 v[36:39], a[40:43], a[108:111], v[36:39]
    v_fmac_f32 v211, v127, v79
    v_add_f32 v209, v209, v71
    v_mfma_f32_16x16x32_bf16 v[36:39], a[44:47], a[104:107], v[36:39]
    s_waitcnt lgkmcnt(3)
    v_fmac_f32 v210, v128, v88
    v_add_f32_e64 v208, v208, v80
    v_mfma_f32_16x16x32_bf16 v[36:39], a[48:51], a[100:103], v[36:39]
    v_fmac_f32 v211, v129, v89
    v_add_f32 v209, v209, v81
    v_mfma_f32_16x16x32_bf16 v[36:39], a[52:55], a[96:99], v[36:39]
    v_fmac_f32 v210, v130, v90
    v_add_f32 v208, v208, v82
    v_mfma_f32_16x16x32_bf16 v[40:43], a[32:35], a[120:123], v[40:43]
    v_fmac_f32 v211, v131, v91
    v_add_f32 v209, v209, v83
    v_mfma_f32_16x16x32_bf16 v[40:43], a[36:39], a[116:119], v[40:43]
    s_waitcnt lgkmcnt(2)
    v_fmac_f32 v210, v132, v92
    v_add_f32_e64 v208, v208, v84
    v_mfma_f32_16x16x32_bf16 v[40:43], a[40:43], a[112:115], v[40:43]
    v_fmac_f32 v211, v133, v93
    v_add_f32 v209, v209, v85
    v_mfma_f32_16x16x32_bf16 v[40:43], a[44:47], a[108:111], v[40:43]
    v_fmac_f32 v210, v134, v94
    v_add_f32 v208, v208, v86
    v_mfma_f32_16x16x32_bf16 v[40:43], a[48:51], a[104:107], v[40:43]
    v_fmac_f32 v211, v135, v95
    v_add_f32 v209, v209, v87
    v_mfma_f32_16x16x32_bf16 v[40:43], a[52:55], a[100:103], v[40:43]
    s_waitcnt lgkmcnt(1)
    v_fmac_f32 v210, v136, v104
    v_add_f32_e64 v208, v208, v96
    v_mfma_f32_16x16x32_bf16 v[40:43], a[56:59], a[96:99], v[40:43]
    v_fmac_f32 v211, v137, v105
    v_add_f32 v209, v209, v97
    v_mfma_f32_16x16x32_bf16 v[44:47], a[32:35], a[124:127], v[44:47]
    v_fmac_f32 v210, v138, v106
    v_add_f32 v208, v208, v98
    v_mfma_f32_16x16x32_bf16 v[44:47], a[36:39], a[120:123], v[44:47]
    v_fmac_f32 v211, v139, v107
    v_add_f32 v209, v209, v99
    v_mfma_f32_16x16x32_bf16 v[44:47], a[40:43], a[116:119], v[44:47]
    s_waitcnt lgkmcnt(0)
    v_fmac_f32 v210, v140, v108
    v_add_f32_e64 v208, v208, v100
    v_mfma_f32_16x16x32_bf16 v[44:47], a[44:47], a[112:115], v[44:47]
    v_fmac_f32 v211, v141, v109
    v_add_f32 v209, v209, v101
    v_mfma_f32_16x16x32_bf16 v[44:47], a[48:51], a[108:111], v[44:47]
    v_fmac_f32 v210, v142, v110
    v_add_f32 v208, v208, v102
    v_mfma_f32_16x16x32_bf16 v[44:47], a[52:55], a[104:107], v[44:47]
    v_fmac_f32 v211, v143, v111
    v_add_f32 v209, v209, v103
    v_mfma_f32_16x16x32_bf16 v[44:47], a[56:59], a[100:103], v[44:47]
    v_mfma_f32_16x16x32_bf16 v[44:47], a[60:63], a[96:99], v[44:47]
    buffer_load_dword v247, v246, s[64:67], s93 offen sc1
    ds_write_b128 v226, v[16:19] offset:0
    v_add_f32 v208, v208, v209
    v_add_f32 v210, v210, v211
    v_mov_b32 v209, v208
    v_mov_b32 v211, v210
    v_lshlrev_b32_e64 v2, 2, v1
    ds_write_b128 v226, v[20:23] offset:1280
    s_nop 0
    v_permlane32_swap_b32 v208, v209
    v_permlane32_swap_b32 v210, v211
    v_add_f32 v208, v208, v209
    v_add_f32_e64 v210, v210, v211
    ds_write_b128 v226, v[24:27] offset:2560
    v_cvt_pk_bf16_f32 v208, v208, v210
    s_mov_b32 exec_hi, 0
    buffer_store_dword v208, v2, s[68:71], s88 offen sc1
    s_mov_b64 exec, -1
    ds_write_b128 v226, v[28:31] offset:3840
    ds_write_b128 v226, v[32:35] offset:5120
    ds_write_b128 v226, v[36:39] offset:6400
    ds_write_b128 v226, v[40:43] offset:7680
    ds_write_b128 v226, v[44:47] offset:8960
    s_mul_i32 s80, s74, 12288
    s_add_u32 s80, s80, 1048576
    s_waitcnt lgkmcnt(0)
    s_barrier
    ds_read_b128 v[16:19], v227 offset:4096
    ds_read_b128 v[24:27], v227 offset:14336
    ds_read_b128 v[20:23], v227 offset:4416
    ds_read_b128 v[28:31], v227 offset:14656
    ds_read_b128 v[32:35], v227 offset:24576
    ds_read_b128 v[40:43], v227 offset:34816
    ds_read_b128 v[36:39], v227 offset:24896
    ds_read_b128 v[44:47], v227 offset:35136
    s_waitcnt lgkmcnt(6)
    v_pk_add_f32 v[16:17], v[16:17], v[24:25]
    v_pk_add_f32 v[18:19], v[18:19], v[26:27]
    s_waitcnt lgkmcnt(4)
    v_pk_add_f32 v[20:21], v[20:21], v[28:29]
    v_pk_add_f32 v[22:23], v[22:23], v[30:31]
    v_pk_fma_f32 v[16:17], v[16:17], v[236:237], v[192:193] op_sel:[0,0,0] op_sel_hi:[1,0,1]
    v_pk_fma_f32 v[18:19], v[18:19], v[236:237], v[194:195] op_sel:[0,0,0] op_sel_hi:[1,0,1]
    v_pk_fma_f32 v[20:21], v[20:21], v[236:237], v[196:197] op_sel:[0,0,0] op_sel_hi:[1,0,1]
    v_pk_fma_f32 v[22:23], v[22:23], v[236:237], v[198:199] op_sel:[0,0,0] op_sel_hi:[1,0,1]
    v_cvt_pk_bf16_f32 v4, v16, v17
    v_cvt_pk_bf16_f32 v5, v18, v19
    v_cvt_pk_bf16_f32 v6, v20, v21
    v_cvt_pk_bf16_f32 v7, v22, v23
    buffer_store_dwordx4 v[4:7], v229, s[64:67], s80 offen offset:0 sc1
    s_waitcnt lgkmcnt(2)
    v_pk_add_f32 v[32:33], v[32:33], v[40:41]
    v_pk_add_f32 v[34:35], v[34:35], v[42:43]
    s_waitcnt lgkmcnt(0)
    v_pk_add_f32 v[36:37], v[36:37], v[44:45]
    v_pk_add_f32 v[38:39], v[38:39], v[46:47]
    v_pk_fma_f32 v[32:33], v[32:33], v[236:237], v[200:201] op_sel:[0,1,0] op_sel_hi:[1,1,1]
    v_pk_fma_f32 v[34:35], v[34:35], v[236:237], v[202:203] op_sel:[0,1,0] op_sel_hi:[1,1,1]
    v_pk_fma_f32 v[36:37], v[36:37], v[236:237], v[204:205] op_sel:[0,1,0] op_sel_hi:[1,1,1]
    v_pk_fma_f32 v[38:39], v[38:39], v[236:237], v[206:207] op_sel:[0,1,0] op_sel_hi:[1,1,1]
    v_cvt_pk_bf16_f32 v8, v32, v33
    v_cvt_pk_bf16_f32 v9, v34, v35
    v_cvt_pk_bf16_f32 v10, v36, v37
    v_cvt_pk_bf16_f32 v11, v38, v39
    buffer_store_dwordx4 v[8:11], v229, s[64:67], s80 offen offset:64 sc1
    s_lshr_b32 s81, s73, 2
    s_lshr_b32 s82, s72, 1
    s_lshl3_add_u32 s82, s82, s81
    s_and_b32 s81, s73, 3
    s_and_b32 s83, s72, 1
    s_lshl2_add_u32 s81, s83, s81
    s_mul_i32 s83, s75, 28672
    s_mul_i32 s14, s82, 229376
    s_add_u32 s14, s14, s83
    s_add_u32 s14, s14, 12582912
    s_mul_i32 s16, s81, 229376
    s_add_u32 s16, s16, s83
    s_add_u32 s16, s16, 10485760
    s_add_u32 s17, s16, 114688
    s_bitcmp1_b32 s75, 0
    s_cselect_b32 s13, 0, 0
    s_add_u32 s16, s16, s13
    s_sub_u32 s17, s17, s13
    s_lshl2_add_u32 s13, s82, s75
    s_lshl_b32 s13, s13, 10
    s_add_u32 s13, s13, 131072
    s_mov_b32 s52, s76
    s_mov_b32 s53, s76
    s_lshl_b32 s18, s82, 1
    s_and_b32 s83, s75, 1
    s_lshl_b32 s83, s83, 1
    s_lshl2_add_u32 s19, s81, s83
    s_lshr_b32 s83, s75, 1
    s_add_u32 s19, s19, s83
    s_mov_b32 s83, 0
    v_lshlrev_b32 v2, 4, v1
    v_xor_b32 v14, s83, v2
    s_mov_b32 s21, 1
L_fd_chk:
    s_waitcnt vmcnt(3)
    v_cmp_ne_u32 vcc, v251, v247
    s_nop 0
    s_cbranch_vccnz L_fd_retry
L_fd_ok:
    s_add_u32 s34, s16, 0
    buffer_load_dwordx4 a[0:3], v14, s[64:67], s34 offen offset:0 sc1
    s_add_u32 s35, s17, 0
    buffer_load_dwordx4 a[4:7], v14, s[64:67], s35 offen offset:0 sc1
    buffer_load_dwordx4 a[8:11], v14, s[64:67], s34 offen offset:1024 sc1
    buffer_load_dwordx4 a[12:15], v14, s[64:67], s35 offen offset:1024 sc1
    buffer_load_dwordx4 a[16:19], v14, s[64:67], s34 offen offset:2048 sc1
    s_cmp_lg_u32 s75, 3
    s_waitcnt vmcnt(5)
    s_barrier
    s_cbranch_scc1 L_nofx
    s_mov_b64 exec, 0xf
    buffer_store_dwordx4 v[248:251], v231, s[64:67], s40 offen sc1
    s_mov_b64 exec, -1
    s_cmp_lg_u32 s2, 0
    s_cbranch_scc1 L_nofx
    s_mov_b64 exec, 1
    buffer_store_dword v251, v231, s[64:67], 0 offen
    s_mov_b64 exec, -1
L_nofx:
    buffer_load_dwordx4 a[20:23], v14, s[64:67], s35 offen offset:2048 sc1
    s_lshr_b32 s80, s72, 2
    s_lshl_b32 s80, s80, 5
    s_lshr_b32 s81, s73, 2
    s_lshl2_add_u32 s80, s81, s80
    buffer_load_dwordx4 a[24:27], v14, s[64:67], s34 offen offset:3072 sc1
    s_add_u32 s80, s80, s75
    s_and_b32 s81, s72, 3
    s_and_b32 s83, s73, 3
    s_lshl2_add_u32 s82, s81, s83
    buffer_load_dwordx4 a[28:31], v14, s[64:67], s35 offen offset:3072 sc1
    v_lshrrev_b32 v12, 3, v1
    v_xor_b32 v13, s80, v12
    v_mul_u32_u24 v12, 96, v12
    s_add_u32 s34, s16, 4096
    buffer_load_dwordx4 a[32:35], v14, s[64:67], s34 offen offset:0 sc1
    v_add_u32 v12, v12, v13
    v_and_b32 v13, 7, v1
    v_lshl_add_u32 v13, v12, 3, v13
    s_add_u32 s35, s17, 4096
    buffer_load_dwordx4 a[36:39], v14, s[64:67], s35 offen offset:0 sc1
    v_lshlrev_b32_e64 v13, 4, v13
    s_mul_i32 s9, s82, 236544
    s_add_u32 s9, s9, 6291456
    buffer_load_dwordx4 a[40:43], v14, s[64:67], s34 offen offset:1024 sc1
    s_mul_i32 s11, s75, 16384
    s_mul_i32 s10, s80, 112
    s_mul_i32 s82, s82, 7
    buffer_load_dwordx4 a[44:47], v14, s[64:67], s35 offen offset:1024 sc1
    s_add_u32 s10, s10, s82
    s_lshl_b32 s10, s10, 10
    s_add_u32 s10, s10, 12582912
    buffer_load_dwordx4 a[48:51], v14, s[64:67], s34 offen offset:2048 sc1
    s_lshr_b32 s12, s80, 1
    s_lshl2_add_u32 s12, s12, s81
    s_lshl_b32 s12, s12, 10
    buffer_load_dwordx4 a[52:55], v14, s[64:67], s35 offen offset:2048 sc1
    s_and_b32 s80, s80, 1
    s_lshl2_add_u32 s80, s80, s83
    s_lshl2_add_u32 s12, s80, s12
    buffer_load_dwordx4 a[56:59], v14, s[64:67], s34 offen offset:3072 sc1
    s_add_u32 s12, s12, 131072
    s_mul_i32 s22, s75, 2048
    s_add_u32 s23, s22, s9
    buffer_load_dwordx4 a[60:63], v14, s[64:67], s35 offen offset:3072 sc1
    s_mul_i32 s24, s75, 4096
    s_add_u32 s25, s24, s9
    v_lshlrev_b32 v2, 4, v1
    s_add_u32 s34, s16, 8192
    buffer_load_dwordx4 a[64:67], v14, s[64:67], s34 offen offset:0 sc1
    v_lshrrev_b32_e64 v8, 5, v1
    v_bfe_u32 v9, v1, 2, 2
    v_lshl_add_u32 v8, v8, 3, v9
    s_add_u32 s35, s17, 8192
    buffer_load_dwordx4 a[68:71], v14, s[64:67], s35 offen offset:0 sc1
    v_bfe_u32 v9, v1, 4, 1
    v_lshl_add_u32 v8, v8, 1, v9
    v_and_b32_e64 v10, 3, v1
    buffer_load_dwordx4 a[72:75], v14, s[64:67], s34 offen offset:1024 sc1
    v_lshl_add_u32 v8, v8, 2, v10
    v_lshl_add_u32 v253, v8, 3, s11
    v_add_u32 v3, 65536, v2
    buffer_load_dwordx4 a[76:79], v14, s[64:67], s35 offen offset:1024 sc1
    v_add_u32 v7, 131072, v2
    v_and_b32 v8, 31, v1
    v_and_b32 v10, 32, v1
    buffer_load_dwordx4 a[80:83], v14, s[64:67], s34 offen offset:2048 sc1
    v_lshlrev_b32_e64 v10, 4, v10
    v_lshl_add_u32 v8, v8, 2, v10
    v_add_u32 v249, 65536, v8
    buffer_load_dwordx4 a[84:87], v14, s[64:67], s35 offen offset:2048 sc1
    v_add_u32 v250, 131072, v8
    v_and_b32 v8, 15, v1
    v_cmp_eq_u32 vcc, v8, v9
    buffer_load_dwordx4 a[88:91], v14, s[64:67], s34 offen offset:3072 sc1
    v_mov_b32 v10, 0x3f803f80
    v_and_b32 v254, 7, v1
    v_lshlrev_b32 v254, 2, v254
    buffer_load_dwordx4 a[92:95], v14, s[64:67], s35 offen offset:3072 sc1
    v_cndmask_b32 v56, 0, v10, vcc
    v_cndmask_b32 v57, 0, v10, vcc
    v_cndmask_b32_e64 v58, 0, v10, vcc
    s_add_u32 s34, s16, 12288
    buffer_load_dwordx4 a[96:99], v14, s[64:67], s34 offen offset:0 sc1
    v_cndmask_b32 v59, 0, v10, vcc
    v_lshlrev_b32 v246, 6, v0
    s_mov_b32 s99, 327680
    buffer_load_dword v247, v246, s[64:67], s99 offen sc1
    s_add_u32 s35, s17, 12288
    buffer_load_dwordx4 a[100:103], v14, s[64:67], s35 offen offset:0 sc1
    buffer_load_dwordx4 a[104:107], v14, s[64:67], s34 offen offset:1024 sc1
    buffer_load_dwordx4 a[108:111], v14, s[64:67], s35 offen offset:1024 sc1
    buffer_load_dwordx4 a[112:115], v14, s[64:67], s34 offen offset:2048 sc1
    buffer_load_dwordx4 a[116:119], v14, s[64:67], s35 offen offset:2048 sc1
    buffer_load_dwordx4 a[120:123], v14, s[64:67], s34 offen offset:3072 sc1
    buffer_load_dwordx4 a[124:127], v14, s[64:67], s35 offen offset:3072 sc1
    s_add_u32 s34, s16, 16384
    buffer_load_dwordx4 a[128:131], v14, s[64:67], s34 offen offset:0 sc1
    s_add_u32 s35, s17, 16384
    buffer_load_dwordx4 a[132:135], v14, s[64:67], s35 offen offset:0 sc1
L_fx_chk:
    s_waitcnt vmcnt(9)
    v_cmp_ne_u32 vcc, v251, v247
    s_nop 0
    s_cbranch_vccnz L_fx_retry
L_fx_ok:
    s_barrier
    s_add_u32 m0, s22, 65536
    s_add_u32 s80, s23, 0
    buffer_load_dwordx4 v2, s[64:67], s80 offen offset:0 sc1 lds
    buffer_load_dwordx4 v2, s[64:67], s80 offen offset:1024 sc1 lds
    s_add_u32 m0, s11, 0
    s_mov_b32 s8, 1048576
    buffer_load_dwordx4 v13, s[64:67], s8 offen offset:0 sc1 lds
    s_mov_b32 s8, 1145856
    buffer_load_dwordx4 v13, s[64:67], s8 offen offset:1024 sc1 lds
    s_mov_b32 s8, 1243136
    buffer_load_dwordx4 v13, s[64:67], s8 offen offset:2048 sc1 lds
    s_add_u32 m0, s22, 73728
    s_add_u32 s80, s23, 8192
    buffer_load_dwordx4 v2, s[64:67], s80 offen offset:0 sc1 lds
    buffer_load_dwordx4 v2, s[64:67], s80 offen offset:1024 sc1 lds
    s_add_u32 m0, s11, 0
    s_mov_b32 s8, 1340416
    buffer_load_dwordx4 v13, s[64:67], s8 offen offset:3072 sc1 lds
    s_add_u32 m0, s11, 4096
    s_mov_b32 s8, 1441792
    buffer_load_dwordx4 v13, s[64:67], s8 offen offset:0 sc1 lds
    s_mov_b32 s8, 1539072
    buffer_load_dwordx4 v13, s[64:67], s8 offen offset:1024 sc1 lds
    s_mov_b32 s8, 1636352
    buffer_load_dwordx4 v13, s[64:67], s8 offen offset:2048 sc1 lds
    s_add_u32 m0, s24, 81920
    s_add_u32 s80, s25, 16384
    buffer_load_dwordx4 v2, s[64:67], s80 offen offset:0 sc1 lds
    buffer_load_dwordx4 v2, s[64:67], s80 offen offset:1024 sc1 lds
    buffer_load_dwordx4 v2, s[64:67], s80 offen offset:2048 sc1 lds
    buffer_load_dwordx4 v2, s[64:67], s80 offen offset:3072 sc1 lds
    s_add_u32 m0, s11, 4096
    s_mov_b32 s8, 1733632
    buffer_load_dwordx4 v13, s[64:67], s8 offen offset:3072 sc1 lds
    s_waitcnt vmcnt(14)
    s_barrier
    s_waitcnt vmcnt(13)
    ds_read_b64_tr_b16 v[120:121], v253 offset:0
    ds_read_b64_tr_b16 v[122:123], v253 offset:256
    s_waitcnt vmcnt(12)
    ds_read_b64_tr_b16 v[124:125], v253 offset:1024
    ds_read_b64_tr_b16 v[126:127], v253 offset:1280
    ds_read_b128 v[20:23], v3 offset:0
    ds_read_b128 v[24:27], v3 offset:1024
    ds_read_b128 v[28:31], v3 offset:2048
    ds_read_b128 v[32:35], v3 offset:3072
    ds_read_b128 v[36:39], v3 offset:4096
    ds_read_b128 v[40:43], v3 offset:5120
    s_waitcnt lgkmcnt(2)
    v_mfma_f32_32x32x16_bf16 v[72:87], v[20:23], v[120:123], 0
    s_waitcnt vmcnt(11)
    ds_read_b64_tr_b16 v[128:129], v253 offset:2048
    ds_read_b64_tr_b16 v[130:131], v253 offset:2304
    ds_read_b128 v[20:23], v3 offset:6144
    v_mfma_f32_32x32x16_bf16 v[88:103], v[24:27], v[120:123], 0
    ds_read_b128 v[24:27], v3 offset:7168
    s_add_u32 m0, s11, 8192
    s_mov_b32 s8, 1835008
    buffer_load_dwordx4 v13, s[64:67], s8 offen offset:0 sc1 lds
    v_mfma_f32_4x4x4_16b_bf16 v[48:51], v[120:121], v[120:121], 0
    v_mfma_f32_4x4x4_16b_bf16 v[16:19], v[122:123], v[122:123], 0
    v_mfma_f32_16x16x32_bf16 v[52:55], v[56:59], v[120:123], 0
    v_mfma_f32_32x32x16_bf16 v[72:87], v[28:31], v[124:127], v[72:87]
    s_waitcnt vmcnt(9)
    ds_read_b64_tr_b16 v[132:133], v253 offset:3072
    ds_read_b64_tr_b16 v[134:135], v253 offset:3328
    s_barrier
    ds_read_b128 v[28:31], v3 offset:8192
    s_mov_b32 s8, 1932288
    buffer_load_dwordx4 v13, s[64:67], s8 offen offset:1024 sc1 lds
    v_mfma_f32_32x32x16_bf16 v[88:103], v[32:35], v[124:127], v[88:103]
    ds_read_b128 v[32:35], v3 offset:9216
    s_mov_b32 s8, 2029568
    buffer_load_dwordx4 v13, s[64:67], s8 offen offset:2048 sc1 lds
    v_mfma_f32_4x4x4_16b_bf16 v[48:51], v[124:125], v[124:125], v[48:51]
    v_mfma_f32_4x4x4_16b_bf16 v[16:19], v[126:127], v[126:127], v[16:19]
    v_mfma_f32_16x16x32_bf16 v[52:55], v[56:59], v[124:127], v[52:55]
    s_waitcnt lgkmcnt(4)
    v_mfma_f32_32x32x16_bf16 v[72:87], v[36:39], v[128:131], v[72:87]
    s_waitcnt vmcnt(10)
    ds_read_b64_tr_b16 v[136:137], v253 offset:4096
    ds_read_b64_tr_b16 v[138:139], v253 offset:4352
    ds_read_b128 v[36:39], v3 offset:10240
    s_mov_b32 s8, 2126848
    buffer_load_dwordx4 v13, s[64:67], s8 offen offset:3072 sc1 lds
    v_mfma_f32_32x32x16_bf16 v[88:103], v[40:43], v[128:131], v[88:103]
    ds_read_b128 v[40:43], v3 offset:11264
    v_mfma_f32_4x4x4_16b_bf16 v[48:51], v[128:129], v[128:129], v[48:51]
    v_mfma_f32_4x4x4_16b_bf16 v[16:19], v[130:131], v[130:131], v[16:19]
    v_mfma_f32_16x16x32_bf16 v[52:55], v[56:59], v[128:131], v[52:55]
    s_waitcnt lgkmcnt(6)
    v_mfma_f32_32x32x16_bf16 v[72:87], v[20:23], v[132:135], v[72:87]
    s_waitcnt vmcnt(10)
    ds_read_b64_tr_b16 v[140:141], v253 offset:5120
    ds_read_b64_tr_b16 v[142:143], v253 offset:5376
    ds_read_b128 v[20:23], v3 offset:12288
    s_add_u32 m0, s11, 12288
    s_mov_b32 s8, 2228224
    buffer_load_dwordx4 v13, s[64:67], s8 offen offset:0 sc1 lds
    v_mfma_f32_32x32x16_bf16 v[88:103], v[24:27], v[132:135], v[88:103]
    ds_read_b128 v[24:27], v3 offset:13312
    s_mov_b32 s8, 2325504
    buffer_load_dwordx4 v13, s[64:67], s8 offen offset:1024 sc1 lds
    v_mfma_f32_4x4x4_16b_bf16 v[48:51], v[132:133], v[132:133], v[48:51]
    v_mfma_f32_4x4x4_16b_bf16 v[16:19], v[134:135], v[134:135], v[16:19]
    v_mfma_f32_16x16x32_bf16 v[52:55], v[56:59], v[132:135], v[52:55]
    s_waitcnt lgkmcnt(4)
    v_mfma_f32_32x32x16_bf16 v[72:87], v[28:31], v[136:139], v[72:87]
    s_waitcnt vmcnt(11)
    ds_read_b64_tr_b16 v[144:145], v253 offset:6144
    ds_read_b64_tr_b16 v[146:147], v253 offset:6400
    ds_read_b128 v[28:31], v3 offset:14336
    s_mov_b32 s8, 2422784
    buffer_load_dwordx4 v13, s[64:67], s8 offen offset:2048 sc1 lds
    v_mfma_f32_32x32x16_bf16 v[88:103], v[32:35], v[136:139], v[88:103]
    ds_read_b128 v[32:35], v3 offset:15360
    s_add_u32 m0, s24, 98304
    s_add_u32 s80, s25, 32768
    buffer_load_dwordx4 v2, s[64:67], s80 offen offset:0 sc1 lds
    v_mfma_f32_4x4x4_16b_bf16 v[48:51], v[136:137], v[136:137], v[48:51]
    v_mfma_f32_4x4x4_16b_bf16 v[16:19], v[138:139], v[138:139], v[16:19]
    v_mfma_f32_16x16x32_bf16 v[52:55], v[56:59], v[136:139], v[52:55]
    s_waitcnt lgkmcnt(6)
    v_mfma_f32_32x32x16_bf16 v[72:87], v[36:39], v[140:143], v[72:87]
    s_waitcnt vmcnt(8)
    ds_read_b64_tr_b16 v[148:149], v253 offset:7168
    ds_read_b64_tr_b16 v[150:151], v253 offset:7424
    s_barrier
    ds_read_b128 v[36:39], v3 offset:16384
    v_mfma_f32_32x32x16_bf16 v[88:103], v[40:43], v[140:143], v[88:103]
    ds_read_b128 v[40:43], v3 offset:17408
    buffer_load_dwordx4 v2, s[64:67], s80 offen offset:1024 sc1 lds
    v_mfma_f32_4x4x4_16b_bf16 v[48:51], v[140:141], v[140:141], v[48:51]
    v_mfma_f32_4x4x4_16b_bf16 v[16:19], v[142:143], v[142:143], v[16:19]
    v_mfma_f32_16x16x32_bf16 v[52:55], v[56:59], v[140:143], v[52:55]
    s_waitcnt lgkmcnt(4)
    v_mfma_f32_32x32x16_bf16 v[72:87], v[20:23], v[144:147], v[72:87]
    s_waitcnt vmcnt(8)
    ds_read_b64_tr_b16 v[152:153], v253 offset:8192
    ds_read_b64_tr_b16 v[154:155], v253 offset:8448
    ds_read_b128 v[20:23], v3 offset:18432
    buffer_load_dwordx4 v2, s[64:67], s80 offen offset:2048 sc1 lds
    v_mfma_f32_32x32x16_bf16 v[88:103], v[24:27], v[144:147], v[88:103]
    ds_read_b128 v[24:27], v3 offset:19456
    buffer_load_dwordx4 v2, s[64:67], s80 offen offset:3072 sc1 lds
    v_mfma_f32_4x4x4_16b_bf16 v[48:51], v[144:145], v[144:145], v[48:51]
    v_mfma_f32_4x4x4_16b_bf16 v[16:19], v[146:147], v[146:147], v[16:19]
    v_mfma_f32_16x16x32_bf16 v[52:55], v[56:59], v[144:147], v[52:55]
    s_waitcnt lgkmcnt(6)
    v_mfma_f32_32x32x16_bf16 v[72:87], v[28:31], v[148:151], v[72:87]
    s_waitcnt vmcnt(9)
    ds_read_b64_tr_b16 v[156:157], v253 offset:9216
    ds_read_b64_tr_b16 v[158:159], v253 offset:9472
    ds_read_b128 v[28:31], v3 offset:20480
    s_add_u32 m0, s11, 12288
    s_mov_b32 s8, 2520064
    buffer_load_dwordx4 v13, s[64:67], s8 offen offset:3072 sc1 lds
    v_mfma_f32_32x32x16_bf16 v[88:103], v[32:35], v[148:151], v[88:103]
    ds_read_b128 v[32:35], v3 offset:21504
    v_mfma_f32_4x4x4_16b_bf16 v[48:51], v[148:149], v[148:149], v[48:51]
    v_mfma_f32_4x4x4_16b_bf16 v[16:19], v[150:151], v[150:151], v[16:19]
    v_mfma_f32_16x16x32_bf16 v[52:55], v[56:59], v[148:151], v[52:55]
    s_waitcnt lgkmcnt(4)
    v_mfma_f32_32x32x16_bf16 v[72:87], v[36:39], v[152:155], v[72:87]
    s_waitcnt vmcnt(9)
    ds_read_b64_tr_b16 v[160:161], v253 offset:10240
    ds_read_b64_tr_b16 v[162:163], v253 offset:10496
    ds_read_b128 v[36:39], v3 offset:22528
    s_add_u32 m0, s11, 0
    s_mov_b32 s8, 2621440
    buffer_load_dwordx4 v13, s[64:67], s8 offen offset:0 sc1 lds
    v_mfma_f32_32x32x16_bf16 v[88:103], v[40:43], v[152:155], v[88:103]
    ds_read_b128 v[40:43], v3 offset:23552
    s_mov_b32 s8, 2718720
    buffer_load_dwordx4 v13, s[64:67], s8 offen offset:1024 sc1 lds
    v_mfma_f32_4x4x4_16b_bf16 v[48:51], v[152:153], v[152:153], v[48:51]
    v_mfma_f32_4x4x4_16b_bf16 v[16:19], v[154:155], v[154:155], v[16:19]
    v_mfma_f32_16x16x32_bf16 v[52:55], v[56:59], v[152:155], v[52:55]
    s_waitcnt lgkmcnt(6)
    v_mfma_f32_32x32x16_bf16 v[72:87], v[20:23], v[156:159], v[72:87]
    s_waitcnt vmcnt(10)
    ds_read_b64_tr_b16 v[164:165], v253 offset:11264
    ds_read_b64_tr_b16 v[166:167], v253 offset:11520
    ds_read_b128 v[20:23], v3 offset:24576
    s_mov_b32 s8, 2816000
    buffer_load_dwordx4 v13, s[64:67], s8 offen offset:2048 sc1 lds
    v_mfma_f32_32x32x16_bf16 v[88:103], v[24:27], v[156:159], v[88:103]
    ds_read_b128 v[24:27], v3 offset:25600
    s_mov_b32 s8, 2913280
    buffer_load_dwordx4 v13, s[64:67], s8 offen offset:3072 sc1 lds
    v_mfma_f32_4x4x4_16b_bf16 v[48:51], v[156:157], v[156:157], v[48:51]
    v_mfma_f32_4x4x4_16b_bf16 v[16:19], v[158:159], v[158:159], v[16:19]
    v_mfma_f32_16x16x32_bf16 v[52:55], v[56:59], v[156:159], v[52:55]
    s_waitcnt lgkmcnt(4)
    v_mfma_f32_32x32x16_bf16 v[72:87], v[28:31], v[160:163], v[72:87]
    s_waitcnt vmcnt(11)
    ds_read_b64_tr_b16 v[168:169], v253 offset:12288
    ds_read_b64_tr_b16 v[170:171], v253 offset:12544
    ds_read_b128 v[28:31], v3 offset:26624
L_touch2:
    s_cbranch_execz L_touch3
    s_nop 0
    v_mfma_f32_32x32x16_bf16 v[88:103], v[32:35], v[160:163], v[88:103]
    ds_read_b128 v[32:35], v3 offset:27648
    s_add_u32 m0, s11, 4096
    s_mov_b32 s8, 3014656
    buffer_load_dwordx4 v13, s[64:67], s8 offen offset:0 sc1 lds
    v_mfma_f32_4x4x4_16b_bf16 v[48:51], v[160:161], v[160:161], v[48:51]
    v_mfma_f32_4x4x4_16b_bf16 v[16:19], v[162:163], v[162:163], v[16:19]
    v_mfma_f32_16x16x32_bf16 v[52:55], v[56:59], v[160:163], v[52:55]
    s_waitcnt lgkmcnt(6)
    v_mfma_f32_32x32x16_bf16 v[72:87], v[36:39], v[164:167], v[72:87]
    s_waitcnt vmcnt(11)
    ds_read_b64_tr_b16 v[172:173], v253 offset:13312
    ds_read_b64_tr_b16 v[174:175], v253 offset:13568
    ds_read_b128 v[36:39], v3 offset:28672
    s_mov_b32 s8, 3111936
    buffer_load_dwordx4 v13, s[64:67], s8 offen offset:1024 sc1 lds
    v_mfma_f32_32x32x16_bf16 v[88:103], v[40:43], v[164:167], v[88:103]
    ds_read_b128 v[40:43], v3 offset:29696
    s_mov_b32 s8, 3209216
    buffer_load_dwordx4 v13, s[64:67], s8 offen offset:2048 sc1 lds
    v_mfma_f32_4x4x4_16b_bf16 v[48:51], v[164:165], v[164:165], v[48:51]
    v_mfma_f32_4x4x4_16b_bf16 v[16:19], v[166:167], v[166:167], v[16:19]
    v_mfma_f32_16x16x32_bf16 v[52:55], v[56:59], v[164:167], v[52:55]
    s_waitcnt lgkmcnt(4)
    v_mfma_f32_32x32x16_bf16 v[72:87], v[20:23], v[168:171], v[72:87]
    s_waitcnt vmcnt(12)
    ds_read_b64_tr_b16 v[176:177], v253 offset:14336
    ds_read_b64_tr_b16 v[178:179], v253 offset:14592
    ds_read_b128 v[20:23], v3 offset:30720
    s_add_u32 m0, s24, 114688
    s_add_u32 s80, s25, 49152
    buffer_load_dwordx4 v2, s[64:67], s80 offen offset:0 sc1 lds
    v_mfma_f32_32x32x16_bf16 v[88:103], v[24:27], v[168:171], v[88:103]
    ds_read_b128 v[24:27], v3 offset:31744
    v_mfma_f32_4x4x4_16b_bf16 v[48:51], v[168:169], v[168:169], v[48:51]
    v_mfma_f32_4x4x4_16b_bf16 v[16:19], v[170:171], v[170:171], v[16:19]
    v_mfma_f32_16x16x32_bf16 v[52:55], v[56:59], v[168:171], v[52:55]
    s_waitcnt lgkmcnt(6)
    v_mfma_f32_32x32x16_bf16 v[72:87], v[28:31], v[172:175], v[72:87]
    s_waitcnt vmcnt(8)
    ds_read_b64_tr_b16 v[180:181], v253 offset:15360
    ds_read_b64_tr_b16 v[182:183], v253 offset:15616
    s_barrier
    ds_read_b128 v[28:31], v3 offset:32768
    buffer_load_dwordx4 v2, s[64:67], s80 offen offset:1024 sc1 lds
    v_mfma_f32_32x32x16_bf16 v[88:103], v[32:35], v[172:175], v[88:103]
    ds_read_b128 v[32:35], v3 offset:33792
    buffer_load_dwordx4 v2, s[64:67], s80 offen offset:2048 sc1 lds
    v_mfma_f32_4x4x4_16b_bf16 v[48:51], v[172:173], v[172:173], v[48:51]
    v_mfma_f32_4x4x4_16b_bf16 v[16:19], v[174:175], v[174:175], v[16:19]
    v_mfma_f32_16x16x32_bf16 v[52:55], v[56:59], v[172:175], v[52:55]
    s_waitcnt lgkmcnt(4)
    v_mfma_f32_32x32x16_bf16 v[72:87], v[36:39], v[176:179], v[72:87]
    s_waitcnt vmcnt(9)
    ds_read_b64_tr_b16 v[184:185], v253 offset:0
    ds_read_b64_tr_b16 v[186:187], v253 offset:256
    ds_read_b128 v[36:39], v3 offset:34816
    buffer_load_dwordx4 v2, s[64:67], s80 offen offset:3072 sc1 lds
    v_mfma_f32_32x32x16_bf16 v[88:103], v[40:43], v[176:179], v[88:103]
    ds_read_b128 v[40:43], v3 offset:35840
    s_add_u32 m0, s11, 4096
    s_mov_b32 s8, 3306496
    buffer_load_dwordx4 v13, s[64:67], s8 offen offset:3072 sc1 lds
    v_mfma_f32_4x4x4_16b_bf16 v[48:51], v[176:177], v[176:177], v[48:51]
    v_mfma_f32_4x4x4_16b_bf16 v[16:19], v[178:179], v[178:179], v[16:19]
    v_mfma_f32_16x16x32_bf16 v[52:55], v[56:59], v[176:179], v[52:55]
    s_waitcnt lgkmcnt(6)
    v_mfma_f32_32x32x16_bf16 v[72:87], v[20:23], v[180:183], v[72:87]
    s_waitcnt vmcnt(10)
    ds_read_b64_tr_b16 v[188:189], v253 offset:1024
    ds_read_b64_tr_b16 v[190:191], v253 offset:1280
    ds_read_b128 v[20:23], v3 offset:36864
    v_mfma_f32_32x32x16_bf16 v[88:103], v[24:27], v[180:183], v[88:103]
    ds_read_b128 v[24:27], v3 offset:37888
    s_add_u32 m0, s11, 8192
    s_mov_b32 s8, 3407872
    buffer_load_dwordx4 v13, s[64:67], s8 offen offset:0 sc1 lds
    v_mfma_f32_4x4x4_16b_bf16 v[48:51], v[180:181], v[180:181], v[48:51]
    v_mfma_f32_4x4x4_16b_bf16 v[16:19], v[182:183], v[182:183], v[16:19]
    v_mfma_f32_16x16x32_bf16 v[52:55], v[56:59], v[180:183], v[52:55]
    s_waitcnt lgkmcnt(4)
    v_mfma_f32_32x32x16_bf16 v[72:87], v[28:31], v[184:187], v[72:87]
    s_waitcnt vmcnt(10)
    ds_read_b64_tr_b16 v[192:193], v253 offset:2048
    ds_read_b64_tr_b16 v[194:195], v253 offset:2304
    ds_read_b128 v[28:31], v3 offset:38912
    s_mov_b32 s8, 3505152
    buffer_load_dwordx4 v13, s[64:67], s8 offen offset:1024 sc1 lds
    v_mfma_f32_32x32x16_bf16 v[88:103], v[32:35], v[184:187], v[88:103]
    ds_read_b128 v[32:35], v3 offset:39936
    s_mov_b32 s8, 3602432
    buffer_load_dwordx4 v13, s[64:67], s8 offen offset:2048 sc1 lds
    v_mfma_f32_4x4x4_16b_bf16 v[48:51], v[184:185], v[184:185], v[48:51]
    v_mfma_f32_4x4x4_16b_bf16 v[16:19], v[186:187], v[186:187], v[16:19]
    v_mfma_f32_16x16x32_bf16 v[52:55], v[56:59], v[184:187], v[52:55]
    s_waitcnt lgkmcnt(6)
    v_mfma_f32_32x32x16_bf16 v[72:87], v[36:39], v[188:191], v[72:87]
    s_waitcnt vmcnt(11)
    ds_read_b64_tr_b16 v[196:197], v253 offset:3072
    ds_read_b64_tr_b16 v[198:199], v253 offset:3328
    ds_read_b128 v[36:39], v3 offset:40960
    s_mov_b32 s8, 3699712
    buffer_load_dwordx4 v13, s[64:67], s8 offen offset:3072 sc1 lds
    v_mfma_f32_32x32x16_bf16 v[88:103], v[40:43], v[188:191], v[88:103]
    ds_read_b128 v[40:43], v3 offset:41984
    v_mfma_f32_4x4x4_16b_bf16 v[48:51], v[188:189], v[188:189], v[48:51]
    v_mfma_f32_4x4x4_16b_bf16 v[16:19], v[190:191], v[190:191], v[16:19]
    v_mfma_f32_16x16x32_bf16 v[52:55], v[56:59], v[188:191], v[52:55]
    s_waitcnt lgkmcnt(4)
    v_mfma_f32_32x32x16_bf16 v[72:87], v[20:23], v[192:195], v[72:87]
    s_waitcnt vmcnt(11)
    ds_read_b64_tr_b16 v[200:201], v253 offset:4096
    ds_read_b64_tr_b16 v[202:203], v253 offset:4352
    ds_read_b128 v[20:23], v3 offset:43008
    s_add_u32 m0, s11, 12288
    s_mov_b32 s8, 3801088
    buffer_load_dwordx4 v13, s[64:67], s8 offen offset:0 sc1 lds
    v_mfma_f32_32x32x16_bf16 v[88:103], v[24:27], v[192:195], v[88:103]
    ds_read_b128 v[24:27], v3 offset:44032
    s_mov_b32 s8, 3898368
    buffer_load_dwordx4 v13, s[64:67], s8 offen offset:1024 sc1 lds
    v_mfma_f32_4x4x4_16b_bf16 v[48:51], v[192:193], v[192:193], v[48:51]
    v_mfma_f32_4x4x4_16b_bf16 v[16:19], v[194:195], v[194:195], v[16:19]
    v_mfma_f32_16x16x32_bf16 v[52:55], v[56:59], v[192:195], v[52:55]
    s_waitcnt lgkmcnt(6)
    v_mfma_f32_32x32x16_bf16 v[72:87], v[28:31], v[196:199], v[72:87]
    s_waitcnt vmcnt(12)
    ds_read_b64_tr_b16 v[204:205], v253 offset:5120
    ds_read_b64_tr_b16 v[206:207], v253 offset:5376
    ds_read_b128 v[28:31], v3 offset:45056
    s_mov_b32 s8, 3995648
    buffer_load_dwordx4 v13, s[64:67], s8 offen offset:2048 sc1 lds
    v_mfma_f32_32x32x16_bf16 v[88:103], v[32:35], v[196:199], v[88:103]
    ds_read_b128 v[32:35], v3 offset:46080
    s_add_u32 m0, s24, 131072
    s_add_u32 s80, s25, 65536
    buffer_load_dwordx4 v2, s[64:67], s80 offen offset:0 sc1 lds
    v_mfma_f32_4x4x4_16b_bf16 v[48:51], v[196:197], v[196:197], v[48:51]
    v_mfma_f32_4x4x4_16b_bf16 v[16:19], v[198:199], v[198:199], v[16:19]
    v_mfma_f32_16x16x32_bf16 v[52:55], v[56:59], v[196:199], v[52:55]
    s_waitcnt lgkmcnt(4)
    v_mfma_f32_32x32x16_bf16 v[72:87], v[36:39], v[200:203], v[72:87]
    s_waitcnt vmcnt(13)
    ds_read_b64_tr_b16 v[208:209], v253 offset:6144
    ds_read_b64_tr_b16 v[210:211], v253 offset:6400
    ds_read_b128 v[36:39], v3 offset:47104
    v_mfma_f32_32x32x16_bf16 v[88:103], v[40:43], v[200:203], v[88:103]
    ds_read_b128 v[40:43], v3 offset:48128
    buffer_load_dwordx4 v2, s[64:67], s80 offen offset:1024 sc1 lds
    v_mfma_f32_4x4x4_16b_bf16 v[48:51], v[200:201], v[200:201], v[48:51]
    v_mfma_f32_4x4x4_16b_bf16 v[16:19], v[202:203], v[202:203], v[16:19]
    v_mfma_f32_16x16x32_bf16 v[52:55], v[56:59], v[200:203], v[52:55]
    s_waitcnt lgkmcnt(6)
    v_mfma_f32_32x32x16_bf16 v[72:87], v[20:23], v[204:207], v[72:87]
    s_waitcnt vmcnt(9)
    ds_read_b64_tr_b16 v[212:213], v253 offset:7168
    ds_read_b64_tr_b16 v[214:215], v253 offset:7424
    s_barrier
    ds_read_b128 v[20:23], v3 offset:49152
    buffer_load_dwordx4 v2, s[64:67], s80 offen offset:2048 sc1 lds
    v_mfma_f32_32x32x16_bf16 v[88:103], v[24:27], v[204:207], v[88:103]
    ds_read_b128 v[24:27], v3 offset:50176
    buffer_load_dwordx4 v2, s[64:67], s80 offen offset:3072 sc1 lds
    v_mfma_f32_4x4x4_16b_bf16 v[48:51], v[204:205], v[204:205], v[48:51]
    v_mfma_f32_4x4x4_16b_bf16 v[16:19], v[206:207], v[206:207], v[16:19]
    v_mfma_f32_16x16x32_bf16 v[52:55], v[56:59], v[204:207], v[52:55]
    s_waitcnt lgkmcnt(4)
    v_mfma_f32_32x32x16_bf16 v[72:87], v[28:31], v[208:211], v[72:87]
    s_waitcnt vmcnt(10)
    ds_read_b64_tr_b16 v[216:217], v253 offset:8192
    ds_read_b64_tr_b16 v[218:219], v253 offset:8448
    ds_read_b128 v[28:31], v3 offset:51200
    s_add_u32 m0, s11, 12288
    s_mov_b32 s8, 4092928
    buffer_load_dwordx4 v13, s[64:67], s8 offen offset:3072 sc1 lds
    v_mfma_f32_32x32x16_bf16 v[88:103], v[32:35], v[208:211], v[88:103]
    ds_read_b128 v[32:35], v3 offset:52224
    v_mfma_f32_4x4x4_16b_bf16 v[48:51], v[208:209], v[208:209], v[48:51]
    v_mfma_f32_4x4x4_16b_bf16 v[16:19], v[210:211], v[210:211], v[16:19]
    v_mfma_f32_16x16x32_bf16 v[52:55], v[56:59], v[208:211], v[52:55]
    s_waitcnt lgkmcnt(6)
    v_mfma_f32_32x32x16_bf16 v[72:87], v[36:39], v[212:215], v[72:87]
    s_waitcnt vmcnt(10)
    ds_read_b64_tr_b16 v[220:221], v253 offset:9216
    ds_read_b64_tr_b16 v[222:223], v253 offset:9472
    ds_read_b128 v[36:39], v3 offset:53248
    v_mfma_f32_32x32x16_bf16 v[88:103], v[40:43], v[212:215], v[88:103]
    ds_read_b128 v[40:43], v3 offset:54272
    v_mfma_f32_4x4x4_16b_bf16 v[48:51], v[212:213], v[212:213], v[48:51]
    v_mfma_f32_4x4x4_16b_bf16 v[16:19], v[214:215], v[214:215], v[16:19]
    v_mfma_f32_16x16x32_bf16 v[52:55], v[56:59], v[212:215], v[52:55]
    s_waitcnt lgkmcnt(4)
    v_mfma_f32_32x32x16_bf16 v[72:87], v[20:23], v[216:219], v[72:87]
    s_waitcnt vmcnt(9)
    ds_read_b64_tr_b16 v[224:225], v253 offset:10240
    ds_read_b64_tr_b16 v[226:227], v253 offset:10496
    ds_read_b128 v[20:23], v3 offset:55296
    v_mfma_f32_32x32x16_bf16 v[88:103], v[24:27], v[216:219], v[88:103]
    ds_read_b128 v[24:27], v3 offset:56320
    v_mfma_f32_4x4x4_16b_bf16 v[48:51], v[216:217], v[216:217], v[48:51]
    v_mfma_f32_4x4x4_16b_bf16 v[16:19], v[218:219], v[218:219], v[16:19]
    v_mfma_f32_16x16x32_bf16 v[52:55], v[56:59], v[216:219], v[52:55]
    s_waitcnt lgkmcnt(6)
    v_mfma_f32_32x32x16_bf16 v[72:87], v[28:31], v[220:223], v[72:87]
    s_waitcnt vmcnt(8)
    ds_read_b64_tr_b16 v[228:229], v253 offset:11264
    ds_read_b64_tr_b16 v[230:231], v253 offset:11520
    ds_read_b128 v[28:31], v3 offset:57344
    s_add_u32 m0, s24, 147456
    s_add_u32 s80, s25, 81920
    buffer_load_dwordx4 v2, s[64:67], s80 offen offset:0 sc1 lds
    v_mfma_f32_32x32x16_bf16 v[88:103], v[32:35], v[220:223], v[88:103]
    ds_read_b128 v[32:35], v3 offset:58368
    buffer_load_dwordx4 v2, s[64:67], s80 offen offset:1024 sc1 lds
    v_mfma_f32_4x4x4_16b_bf16 v[48:51], v[220:221], v[220:221], v[48:51]
    v_mfma_f32_4x4x4_16b_bf16 v[16:19], v[222:223], v[222:223], v[16:19]
    v_mfma_f32_16x16x32_bf16 v[52:55], v[56:59], v[220:223], v[52:55]
    s_waitcnt lgkmcnt(4)
    v_mfma_f32_32x32x16_bf16 v[72:87], v[36:39], v[224:227], v[72:87]
    s_waitcnt vmcnt(9)
    ds_read_b64_tr_b16 v[232:233], v253 offset:12288
    ds_read_b64_tr_b16 v[234:235], v253 offset:12544
    ds_read_b128 v[36:39], v3 offset:59392
    buffer_load_dwordx4 v2, s[64:67], s80 offen offset:2048 sc1 lds
    v_mfma_f32_32x32x16_bf16 v[88:103], v[40:43], v[224:227], v[88:103]
    ds_read_b128 v[40:43], v3 offset:60416
    buffer_load_dwordx4 v2, s[64:67], s80 offen offset:3072 sc1 lds
    v_mfma_f32_4x4x4_16b_bf16 v[48:51], v[224:225], v[224:225], v[48:51]
    v_mfma_f32_4x4x4_16b_bf16 v[16:19], v[226:227], v[226:227], v[16:19]
    v_mfma_f32_16x16x32_bf16 v[52:55], v[56:59], v[224:227], v[52:55]
    s_waitcnt lgkmcnt(6)
    v_mfma_f32_32x32x16_bf16 v[72:87], v[20:23], v[228:231], v[72:87]
    s_waitcnt vmcnt(10)
    ds_read_b64_tr_b16 v[236:237], v253 offset:13312
    ds_read_b64_tr_b16 v[238:239], v253 offset:13568
    ds_read_b128 v[20:23], v3 offset:61440
    v_mfma_f32_32x32x16_bf16 v[88:103], v[24:27], v[228:231], v[88:103]
    ds_read_b128 v[24:27], v3 offset:62464
    v_mfma_f32_4x4x4_16b_bf16 v[48:51], v[228:229], v[228:229], v[48:51]
    v_mfma_f32_4x4x4_16b_bf16 v[16:19], v[230:231], v[230:231], v[16:19]
    v_mfma_f32_16x16x32_bf16 v[52:55], v[56:59], v[228:231], v[52:55]
    s_waitcnt lgkmcnt(4)
    v_mfma_f32_32x32x16_bf16 v[72:87], v[28:31], v[232:235], v[72:87]
    s_waitcnt vmcnt(9)
    ds_read_b64_tr_b16 v[240:241], v253 offset:14336
    ds_read_b64_tr_b16 v[242:243], v253 offset:14592
    ds_read_b128 v[28:31], v3 offset:63488
    v_mfma_f32_32x32x16_bf16 v[88:103], v[32:35], v[232:235], v[88:103]
    ds_read_b128 v[32:35], v3 offset:64512
    v_mfma_f32_4x4x4_16b_bf16 v[48:51], v[232:233], v[232:233], v[48:51]
    v_mfma_f32_4x4x4_16b_bf16 v[16:19], v[234:235], v[234:235], v[16:19]
    v_mfma_f32_16x16x32_bf16 v[52:55], v[56:59], v[232:235], v[52:55]
    s_waitcnt lgkmcnt(6)
    v_mfma_f32_32x32x16_bf16 v[72:87], v[36:39], v[236:239], v[72:87]
    s_waitcnt vmcnt(4)
    ds_read_b64_tr_b16 v[244:245], v253 offset:15360
    ds_read_b64_tr_b16 v[246:247], v253 offset:15616
    s_barrier
    ds_read_b128 v[36:39], v7 offset:2048
    v_mfma_f32_32x32x16_bf16 v[88:103], v[40:43], v[236:239], v[88:103]
    ds_read_b128 v[40:43], v7 offset:3072
    v_mfma_f32_4x4x4_16b_bf16 v[48:51], v[236:237], v[236:237], v[48:51]
    v_mfma_f32_4x4x4_16b_bf16 v[16:19], v[238:239], v[238:239], v[16:19]
    v_mfma_f32_16x16x32_bf16 v[52:55], v[56:59], v[236:239], v[52:55]
    s_waitcnt lgkmcnt(4)
    v_mfma_f32_32x32x16_bf16 v[72:87], v[20:23], v[240:243], v[72:87]
    ds_read_b128 v[20:23], v7 offset:4096
    v_mfma_f32_32x32x16_bf16 v[88:103], v[24:27], v[240:243], v[88:103]
    ds_read_b128 v[24:27], v7 offset:5120
    v_mfma_f32_4x4x4_16b_bf16 v[48:51], v[240:241], v[240:241], v[48:51]
    v_mfma_f32_4x4x4_16b_bf16 v[16:19], v[242:243], v[242:243], v[16:19]
    v_mfma_f32_16x16x32_bf16 v[52:55], v[56:59], v[240:243], v[52:55]
    s_waitcnt lgkmcnt(4)
    v_mfma_f32_32x32x16_bf16 v[72:87], v[28:31], v[244:247], v[72:87]
    ds_read_b128 v[28:31], v7 offset:6144
    v_mfma_f32_32x32x16_bf16 v[88:103], v[32:35], v[244:247], v[88:103]
    ds_read_b128 v[32:35], v7 offset:7168
    v_mfma_f32_4x4x4_16b_bf16 v[48:51], v[244:245], v[244:245], v[48:51]
    v_mfma_f32_4x4x4_16b_bf16 v[16:19], v[246:247], v[246:247], v[16:19]
    v_mfma_f32_16x16x32_bf16 v[52:55], v[56:59], v[244:247], v[52:55]
    s_waitcnt lgkmcnt(2)
    v_mfma_f32_32x32x16_bf16 v[104:119], v[36:39], v[120:123], 0
    ds_read_b128 v[36:39], v7 offset:8192
    s_add_u32 m0, s24, 65536
    s_add_u32 s80, s25, 98304
    buffer_load_dwordx4 v2, s[64:67], s80 offen offset:0 sc1 lds
    v_and_b32 v11, 15, v1
    v_lshlrev_b32 v11, 2, v11
    v_mfma_f32_32x32x16_bf16 v[104:119], v[40:43], v[124:127], v[104:119]
    ds_read_b128 v[40:43], v7 offset:9216
    buffer_load_dwordx4 v2, s[64:67], s80 offen offset:1024 sc1 lds
    v_and_b32 v8, 3, v1
    v_cmp_eq_u32 vcc, 1, v8
    v_cmp_eq_u32 s[82:83], 2, v8
    v_and_b32_e64 v10, 16, v1
    v_mfma_f32_32x32x16_bf16 v[104:119], v[20:23], v[128:131], v[104:119]
    ds_read_b128 v[20:23], v7 offset:10240
    ds_bpermute_b32 v12, v11, v52
    ds_bpermute_b32 v13, v11, v53
    v_add_f32 v48, v48, v16
    v_add_f32 v49, v49, v17
    v_add_f32_e64 v50, v50, v18
    v_mfma_f32_32x32x16_bf16 v[104:119], v[24:27], v[132:135], v[104:119]
    ds_read_b128 v[24:27], v7 offset:11264
    buffer_load_dwordx4 v2, s[64:67], s80 offen offset:2048 sc1 lds
    v_add_f32 v51, v51, v19
    v_cndmask_b32 v9, v48, v49, vcc
    v_cmp_eq_u32 vcc, 3, v8
    s_waitcnt lgkmcnt(4)
    v_mfma_f32_32x32x16_bf16 v[104:119], v[28:31], v[136:139], v[104:119]
    ds_read_b128 v[28:31], v7 offset:12288
    v_cndmask_b32 v9, v9, v50, s[82:83]
    v_cmp_eq_u32 s[82:83], 0, v10
    v_cndmask_b32_e64 v9, v9, v51, vcc
    v_mov_b32 v8, v9
    v_nop
    v_mfma_f32_32x32x16_bf16 v[104:119], v[32:35], v[140:143], v[104:119]
    ds_read_b128 v[32:35], v7 offset:13312
    buffer_load_dwordx4 v2, s[64:67], s80 offen offset:3072 sc1 lds
    v_nop
    v_permlane32_swap_b32 v8, v9
    v_add_f32 v9, v8, v9
    v_mul_f32 v9, 0x3b000000, v9
    v_mfma_f32_32x32x16_bf16 v[104:119], v[36:39], v[144:147], v[104:119]
    ds_read_b128 v[36:39], v7 offset:14336
    s_waitcnt lgkmcnt(4)
    v_cndmask_b32 v12, v13, v12, s[82:83]
    v_mul_f32 v12, 0x3b000000, v12
    v_fma_f32 v9, -v12, v12, v9
    v_max_f32 v9, 0, v9
    v_cvt_pk_bf16_f32 v9, v9, v9
    v_mfma_f32_32x32x16_bf16 v[104:119], v[40:43], v[148:151], v[104:119]
    ds_read_b128 v[40:43], v7 offset:15360
    s_add_u32 m0, s24, 81920
    s_add_u32 s80, s25, 114688
    buffer_load_dwordx4 v2, s[64:67], s80 offen offset:0 sc1 lds
    v_and_b32 v9, 0xffff0000, v9
    s_waitcnt lgkmcnt(2)
    v_mfma_f32_32x32x16_bf16 v[104:119], v[20:23], v[152:155], v[104:119]
    ds_read_b32 v20, v250 offset:0
    ds_read_b32 v21, v250 offset:128
    ds_read_b32 v22, v250 offset:256
    ds_read_b32 v23, v250 offset:384
    v_add_f32 v9, 0x3727c5ac, v9
    v_cvt_pk_bf16_f32 v9, v9, v9
    v_mfma_f32_32x32x16_bf16 v[104:119], v[24:27], v[156:159], v[104:119]
    ds_read_b32 v24, v250 offset:1024
    ds_read_b32 v25, v250 offset:1152
    ds_read_b32 v26, v250 offset:1280
    ds_read_b32 v27, v250 offset:1408
    buffer_load_dwordx4 a[136:139], v14, s[64:67], s34 offen offset:1024 sc1
    v_and_b32 v9, 0xffff0000, v9
    v_mfma_f32_32x32x16_bf16 v[104:119], v[28:31], v[160:163], v[104:119]
    s_waitcnt vmcnt(6)
    s_barrier
    ds_read_b128 v[28:31], v7 offset:16384
    v_mfma_f32_32x32x16_bf16 v[104:119], v[32:35], v[164:167], v[104:119]
    ds_read_b128 v[32:35], v7 offset:17408
    v_sqrt_f32_e64 v9, v9
    v_nop
    v_cvt_pk_bf16_f32 v44, -v12, v9
    s_waitcnt lgkmcnt(2)
    v_mfma_f32_32x32x16_bf16 v[104:119], v[36:39], v[168:171], v[104:119]
    ds_read_b128 v[36:39], v7 offset:18432
    buffer_load_dwordx4 v2, s[64:67], s80 offen offset:1024 sc1 lds
    v_and_b32 v9, 0xffff0000, v44
    v_mov_b32 v45, v44
    v_rcp_f32 v8, v9
    v_mfma_f32_32x32x16_bf16 v[104:119], v[40:43], v[172:175], v[104:119]
    ds_read_b128 v[40:43], v7 offset:19456
    v_mov_b32 v46, v44
    v_mov_b32 v47, v44
    v_mul_f32_e64 v6, v9, v9
    v_mul_f32 v4, 0xc0135761, v8
    v_mul_f32_e64 v10, v8, v8
    v_mul_f32 v5, 0xbdd2d3e8, v8
    v_mul_f32 v5, v5, v10
    v_mfma_f32_32x32x16_bf16 v[72:87], v[20:23], v[44:47], v[72:87]
    ds_read_b128 v[20:23], v7 offset:20480
    buffer_load_dwordx4 v2, s[64:67], s80 offen offset:2048 sc1 lds
    v_mfma_f32_32x32x16_bf16 v[88:103], v[24:27], v[44:47], v[88:103]
    ds_read_b128 v[24:27], v7 offset:21504
    s_waitcnt lgkmcnt(2)
    v_mfma_f32_32x32x16_bf16 v[104:119], v[28:31], v[176:179], v[104:119]
    ds_read_b128 v[28:31], v7 offset:22528
    buffer_load_dwordx4 v2, s[64:67], s80 offen offset:3072 sc1 lds
    v_mfma_f32_32x32x16_bf16 v[104:119], v[32:35], v[180:183], v[104:119]
    ds_read_b128 v[32:35], v7 offset:23552
    s_nop 1
    v_mul_f32 v8, v72, v72
    v_mul_f32 v9, v73, v73
    v_mul_f32 v10, v74, v74
    v_mul_f32_e64 v11, v75, v75
    v_fma_f32 v8, v8, v5, v4
    v_mfma_f32_32x32x16_bf16 v[104:119], v[36:39], v[184:187], v[104:119]
    ds_read_b128 v[36:39], v7 offset:24576
    s_add_u32 m0, s24, 98304
    s_add_u32 s80, s25, 131072
    buffer_load_dwordx4 v2, s[64:67], s80 offen offset:0 sc1 lds
    v_fma_f32 v9, v9, v5, v4
    v_fma_f32 v10, v10, v5, v4
    v_mfma_f32_32x32x16_bf16 v[104:119], v[40:43], v[188:191], v[104:119]
    ds_read_b128 v[40:43], v7 offset:25600
    v_fma_f32 v11, v11, v5, v4
    v_mul_f32 v8, v8, v72
    v_mul_f32 v9, v9, v73
    v_mul_f32 v10, v10, v74
    s_waitcnt lgkmcnt(2)
    v_mfma_f32_32x32x16_bf16 v[104:119], v[20:23], v[192:195], v[104:119]
    ds_read_b128 v[20:23], v7 offset:26624
    buffer_load_dwordx4 v2, s[64:67], s80 offen offset:1024 sc1 lds
    v_mul_f32 v11, v11, v75
    v_exp_f32 v8, v8
    v_mul_f32_e64 v80, v72, v80
    v_mfma_f32_32x32x16_bf16 v[104:119], v[24:27], v[196:199], v[104:119]
    ds_read_b128 v[24:27], v7 offset:27648
    v_exp_f32 v9, v9
    v_mul_f32 v81, v73, v81
    v_exp_f32_e64 v10, v10
    v_mfma_f32_32x32x16_bf16 v[104:119], v[28:31], v[200:203], v[104:119]
    ds_read_b128 v[28:31], v7 offset:28672
    buffer_load_dwordx4 v2, s[64:67], s80 offen offset:2048 sc1 lds
    v_mul_f32 v82, v74, v82
    v_exp_f32 v11, v11
    v_mul_f32_e64 v83, v75, v83
    v_mfma_f32_32x32x16_bf16 v[104:119], v[32:35], v[204:207], v[104:119]
    ds_read_b128 v[32:35], v7 offset:29696
    v_fma_f32 v72, v8, v6, v6
    v_fma_f32 v73, v9, v6, v6
    v_rcp_f32 v72, v72
    s_waitcnt lgkmcnt(2)
    v_mfma_f32_32x32x16_bf16 v[104:119], v[36:39], v[208:211], v[104:119]
    ds_read_b128 v[36:39], v7 offset:30720
    buffer_load_dwordx4 v2, s[64:67], s80 offen offset:3072 sc1 lds
    v_fma_f32 v74, v10, v6, v6
    v_rcp_f32_e64 v73, v73
    v_fma_f32 v75, v11, v6, v6
    v_mfma_f32_32x32x16_bf16 v[104:119], v[40:43], v[212:215], v[104:119]
    ds_read_b128 v[40:43], v7 offset:31744
    v_rcp_f32 v74, v74
    v_mul_f32 v80, v80, v72
    v_rcp_f32_e64 v75, v75
    v_mfma_f32_32x32x16_bf16 v[104:119], v[20:23], v[216:219], v[104:119]
    s_waitcnt vmcnt(9)
    s_barrier
    ds_read_b128 v[20:23], v3 offset:0
    v_mul_f32_e64 v81, v81, v73
    v_mfma_f32_32x32x16_bf16 v[104:119], v[24:27], v[220:223], v[104:119]
    ds_read_b128 v[24:27], v3 offset:1024
    v_mul_f32_e64 v82, v82, v74
    v_mul_f32 v83, v83, v75
    v_cvt_pk_bf16_f32 v16, v80, v81
    v_cvt_pk_bf16_f32 v17, v82, v83
    s_waitcnt lgkmcnt(2)
    v_mfma_f32_32x32x16_bf16 v[104:119], v[28:31], v[224:227], v[104:119]
    ds_read_b32 v28, v249 offset:2048
    ds_read_b32 v29, v249 offset:2176
    ds_read_b32 v30, v249 offset:2304
    ds_read_b32 v31, v249 offset:2432
    buffer_load_dwordx4 a[140:143], v14, s[64:67], s35 offen offset:1024 sc1
    v_mul_f32_e64 v8, v76, v76
    v_mfma_f32_32x32x16_bf16 v[104:119], v[32:35], v[228:231], v[104:119]
    ds_read_b128 v[32:35], v3 offset:3072
    v_mul_f32 v9, v77, v77
    v_mul_f32 v10, v78, v78
    v_mul_f32_e64 v11, v79, v79
    v_fma_f32 v8, v8, v5, v4
    v_fma_f32 v9, v9, v5, v4
    v_mfma_f32_32x32x16_bf16 v[104:119], v[36:39], v[232:235], v[104:119]
    ds_read_b128 v[36:39], v3 offset:4096
    buffer_load_dwordx4 a[144:147], v14, s[64:67], s34 offen offset:2048 sc1
    v_fma_f32 v10, v10, v5, v4
    v_fma_f32 v11, v11, v5, v4
    v_mul_f32 v8, v8, v76
    v_mul_f32 v9, v9, v77
    v_mfma_f32_32x32x16_bf16 v[104:119], v[40:43], v[236:239], v[104:119]
    ds_read_b128 v[40:43], v3 offset:5120
    v_mul_f32 v10, v10, v78
    v_mul_f32 v11, v11, v79
    v_exp_f32 v8, v8
    s_waitcnt lgkmcnt(2)
    v_mfma_f32_32x32x16_bf16 v[104:119], v[20:23], v[240:243], v[104:119]
    ds_read_b128 v[20:23], v3 offset:6144
    buffer_load_dwordx4 a[148:151], v14, s[64:67], s35 offen offset:2048 sc1
    v_mul_f32 v84, v76, v84
    v_exp_f32 v9, v9
    v_mul_f32_e64 v85, v77, v85
    v_mfma_f32_32x32x16_bf16 v[104:119], v[24:27], v[244:247], v[104:119]
    ds_read_b128 v[24:27], v3 offset:7168
    v_exp_f32 v10, v10
    v_mul_f32 v86, v78, v86
    v_exp_f32_e64 v11, v11
    v_mfma_f32_32x32x16_bf16 v[104:119], v[28:31], v[44:47], v[104:119]
    ds_read_b128 v[28:31], v3 offset:8192
    s_add_u32 m0, s24, 114688
    s_add_u32 s80, s25, 147456
    buffer_load_dwordx4 v2, s[64:67], s80 offen offset:0 sc1 lds
    v_mul_f32_e64 v87, v79, v87
    v_fma_f32 v76, v8, v6, v6
    v_mfma_f32_32x32x16_bf16 v[56:71], v[32:35], v[120:123], 0
    ds_read_b128 v[32:35], v3 offset:9216
    v_fma_f32 v77, v9, v6, v6
    v_rcp_f32 v76, v76
    v_fma_f32 v78, v10, v6, v6
    s_waitcnt lgkmcnt(2)
    v_mfma_f32_32x32x16_bf16 v[56:71], v[36:39], v[124:127], v[56:71]
    ds_read_b128 v[36:39], v3 offset:10240
    buffer_load_dwordx4 v2, s[64:67], s80 offen offset:1024 sc1 lds
    v_rcp_f32_e64 v77, v77
    v_fma_f32 v79, v11, v6, v6
    v_mfma_f32_32x32x16_bf16 v[56:71], v[40:43], v[128:131], v[56:71]
    ds_read_b128 v[40:43], v3 offset:11264
    v_rcp_f32 v78, v78
    v_mul_f32 v84, v84, v76
    v_rcp_f32_e64 v79, v79
    v_mfma_f32_32x32x16_bf16 v[56:71], v[20:23], v[132:135], v[56:71]
    ds_read_b128 v[20:23], v3 offset:12288
    buffer_load_dwordx4 v2, s[64:67], s80 offen offset:2048 sc1 lds
    v_mul_f32 v85, v85, v77
    v_mul_f32 v86, v86, v78
    v_mul_f32_e64 v87, v87, v79
    v_cvt_pk_bf16_f32 v18, v84, v85
    v_mfma_f32_32x32x16_bf16 v[56:71], v[24:27], v[136:139], v[56:71]
    ds_read_b128 v[24:27], v3 offset:13312
    v_cvt_pk_bf16_f32 v19, v86, v87
    v_mul_f32 v8, v88, v88
    v_mul_f32 v9, v89, v89
    v_mul_f32 v10, v90, v90
    s_waitcnt lgkmcnt(2)
    v_mfma_f32_32x32x16_bf16 v[56:71], v[28:31], v[140:143], v[56:71]
    ds_read_b128 v[28:31], v3 offset:14336
    buffer_load_dwordx4 v2, s[64:67], s80 offen offset:3072 sc1 lds
    v_mul_f32_e64 v11, v91, v91
    v_fma_f32 v8, v8, v5, v4
    v_fma_f32 v9, v9, v5, v4
    v_fma_f32 v10, v10, v5, v4
    v_mfma_f32_32x32x16_bf16 v[56:71], v[32:35], v[144:147], v[56:71]
    ds_read_b128 v[32:35], v3 offset:15360
    v_fma_f32 v11, v11, v5, v4
    v_mul_f32 v8, v8, v88
    v_mul_f32 v9, v9, v89
    v_mul_f32 v10, v10, v90
    v_mul_f32 v11, v11, v91
    v_mfma_f32_32x32x16_bf16 v[56:71], v[36:39], v[148:151], v[56:71]
    s_waitcnt vmcnt(11)
    s_barrier
    ds_read_b128 v[36:39], v3 offset:16384
    buffer_store_dwordx4 v[16:19], v2, s[64:67], s10 offen offset:0 sc1
    v_mfma_f32_32x32x16_bf16 v[56:71], v[40:43], v[152:155], v[56:71]
    ds_read_b128 v[40:43], v3 offset:17408
    v_exp_f32_e64 v8, v8
    v_mul_f32 v96, v88, v96
    s_waitcnt lgkmcnt(2)
    v_mfma_f32_32x32x16_bf16 v[56:71], v[20:23], v[156:159], v[56:71]
    ds_read_b128 v[20:23], v3 offset:18432
    v_exp_f32 v9, v9
    v_mul_f32 v97, v89, v97
    v_exp_f32_e64 v10, v10
    v_mfma_f32_32x32x16_bf16 v[56:71], v[24:27], v[160:163], v[56:71]
    ds_read_b128 v[24:27], v3 offset:19456
    v_mul_f32 v98, v90, v98
    v_exp_f32 v11, v11
    v_mul_f32_e64 v99, v91, v99
    v_fma_f32 v88, v8, v6, v6
    v_mfma_f32_32x32x16_bf16 v[56:71], v[28:31], v[164:167], v[56:71]
    ds_read_b128 v[28:31], v3 offset:20480
    v_fma_f32 v89, v9, v6, v6
    v_rcp_f32_e64 v88, v88
    v_fma_f32 v90, v10, v6, v6
    v_mfma_f32_32x32x16_bf16 v[56:71], v[32:35], v[168:171], v[56:71]
    ds_read_b128 v[32:35], v3 offset:21504
    buffer_load_dwordx4 a[152:155], v14, s[64:67], s34 offen offset:3072 sc1
    v_rcp_f32 v89, v89
    v_fma_f32 v91, v11, v6, v6
    s_waitcnt lgkmcnt(2)
    v_mfma_f32_32x32x16_bf16 v[56:71], v[36:39], v[172:175], v[56:71]
L_touch3:
    s_cbranch_execz L_touch4
    s_nop 0
    ds_read_b128 v[36:39], v3 offset:22528
    v_rcp_f32 v90, v90
    v_mul_f32 v96, v96, v88
    v_rcp_f32_e64 v91, v91
    v_mfma_f32_32x32x16_bf16 v[56:71], v[40:43], v[176:179], v[56:71]
    ds_read_b128 v[40:43], v3 offset:23552
    buffer_load_dwordx4 a[156:159], v14, s[64:67], s35 offen offset:3072 sc1
    v_mul_f32 v97, v97, v89
    v_mul_f32 v98, v98, v90
    v_mul_f32_e64 v99, v99, v91
    v_cvt_pk_bf16_f32 v16, v96, v97
    v_mfma_f32_32x32x16_bf16 v[56:71], v[20:23], v[180:183], v[56:71]
    ds_read_b128 v[20:23], v3 offset:24576
    v_cvt_pk_bf16_f32 v17, v98, v99
    v_mul_f32 v8, v92, v92
    v_mul_f32 v9, v93, v93
    v_mul_f32 v10, v94, v94
    v_mul_f32 v11, v95, v95
    v_mfma_f32_32x32x16_bf16 v[56:71], v[24:27], v[184:187], v[56:71]
    ds_read_b128 v[24:27], v3 offset:25600
    s_add_u32 m0, s24, 131072
    s_add_u32 s80, s25, 163840
    buffer_load_dwordx4 v2, s[64:67], s80 offen offset:0 sc1 lds
    v_fma_f32 v8, v8, v5, v4
    s_waitcnt lgkmcnt(2)
    v_mfma_f32_32x32x16_bf16 v[56:71], v[28:31], v[188:191], v[56:71]
    ds_read_b128 v[28:31], v3 offset:26624
    v_fma_f32 v9, v9, v5, v4
    v_fma_f32 v10, v10, v5, v4
    v_fma_f32 v11, v11, v5, v4
    v_mul_f32 v8, v8, v92
    v_mul_f32_e64 v9, v9, v93
    v_mfma_f32_32x32x16_bf16 v[56:71], v[32:35], v[192:195], v[56:71]
    ds_read_b128 v[32:35], v3 offset:27648
    buffer_load_dwordx4 v2, s[64:67], s80 offen offset:1024 sc1 lds
    v_mul_f32 v10, v10, v94
    v_mul_f32 v11, v11, v95
    v_exp_f32_e64 v8, v8
    v_mfma_f32_32x32x16_bf16 v[56:71], v[36:39], v[196:199], v[56:71]
    ds_read_b128 v[36:39], v3 offset:28672
    v_mul_f32 v100, v92, v100
    v_exp_f32 v9, v9
    v_mul_f32_e64 v101, v93, v101
    v_mfma_f32_32x32x16_bf16 v[56:71], v[40:43], v[200:203], v[56:71]
    ds_read_b128 v[40:43], v3 offset:29696
    buffer_load_dwordx4 v2, s[64:67], s80 offen offset:2048 sc1 lds
    v_exp_f32_e64 v10, v10
    v_mul_f32 v102, v94, v102
    s_waitcnt lgkmcnt(2)
    v_mfma_f32_32x32x16_bf16 v[56:71], v[20:23], v[204:207], v[56:71]
    ds_read_b128 v[20:23], v3 offset:30720
    v_exp_f32 v11, v11
    v_mul_f32 v103, v95, v103
    v_fma_f32 v92, v8, v6, v6
    v_fma_f32 v93, v9, v6, v6
    v_mfma_f32_32x32x16_bf16 v[56:71], v[24:27], v[208:211], v[56:71]
    ds_read_b128 v[24:27], v3 offset:31744
    buffer_load_dwordx4 v2, s[64:67], s80 offen offset:3072 sc1 lds
    v_rcp_f32_e64 v92, v92
    v_fma_f32 v94, v10, v6, v6
    v_mfma_f32_32x32x16_bf16 v[56:71], v[28:31], v[212:215], v[56:71]
    s_waitcnt vmcnt(14)
    s_barrier
    ds_read_b128 v[28:31], v3 offset:32768
    v_mfma_f32_32x32x16_bf16 v[56:71], v[32:35], v[216:219], v[56:71]
    ds_read_b128 v[32:35], v3 offset:33792
    v_rcp_f32 v93, v93
    v_fma_f32 v95, v11, v6, v6
    s_waitcnt lgkmcnt(2)
    v_mfma_f32_32x32x16_bf16 v[56:71], v[36:39], v[220:223], v[56:71]
    ds_read_b128 v[36:39], v3 offset:34816
    s_add_u32 s34, s16, 20480
    buffer_load_dwordx4 a[160:163], v14, s[64:67], s34 offen offset:0 sc1
    v_rcp_f32 v94, v94
    v_mul_f32 v100, v100, v92
    v_mfma_f32_32x32x16_bf16 v[56:71], v[40:43], v[224:227], v[56:71]
    ds_read_b32 v40, v249 offset:35840
    ds_read_b32 v41, v249 offset:35968
    ds_read_b32 v42, v249 offset:36096
    ds_read_b32 v43, v249 offset:36224
    v_rcp_f32_e64 v95, v95
    v_mfma_f32_32x32x16_bf16 v[56:71], v[20:23], v[228:231], v[56:71]
    ds_read_b128 v[20:23], v3 offset:36864
    s_add_u32 s35, s17, 20480
    buffer_load_dwordx4 a[164:167], v14, s[64:67], s35 offen offset:0 sc1
    v_mul_f32 v101, v101, v93
    v_mul_f32 v102, v102, v94
    v_mul_f32_e64 v103, v103, v95
    v_mfma_f32_32x32x16_bf16 v[56:71], v[24:27], v[232:235], v[56:71]
    ds_read_b128 v[24:27], v3 offset:37888
    v_cvt_pk_bf16_f32 v18, v100, v101
    v_cvt_pk_bf16_f32 v19, v102, v103
    buffer_store_dwordx4 v[16:19], v2, s[64:67], s10 offen offset:1024 sc1
    v_mul_f32 v8, v104, v104
    s_waitcnt lgkmcnt(2)
    v_mfma_f32_32x32x16_bf16 v[56:71], v[28:31], v[236:239], v[56:71]
    ds_read_b128 v[28:31], v3 offset:38912
    v_mul_f32 v9, v105, v105
    v_mul_f32 v10, v106, v106
    v_mul_f32_e64 v11, v107, v107
    v_fma_f32 v8, v8, v5, v4
    v_fma_f32 v9, v9, v5, v4
    v_mfma_f32_32x32x16_bf16 v[56:71], v[32:35], v[240:243], v[56:71]
    ds_read_b128 v[32:35], v3 offset:39936
    v_fma_f32 v10, v10, v5, v4
    v_fma_f32 v11, v11, v5, v4
    v_mul_f32 v8, v8, v104
    v_mul_f32 v9, v9, v105
    v_mul_f32_e64 v10, v10, v106
    v_mfma_f32_32x32x16_bf16 v[56:71], v[36:39], v[244:247], v[56:71]
    ds_read_b128 v[36:39], v3 offset:40960
    v_mul_f32 v11, v11, v107
    v_exp_f32 v8, v8
    v_mul_f32_e64 v112, v104, v112
    v_mfma_f32_32x32x16_bf16 v[56:71], v[40:43], v[44:47], v[56:71]
    ds_read_b128 v[40:43], v3 offset:41984
    v_exp_f32_e64 v9, v9
    v_mul_f32 v113, v105, v113
    s_waitcnt lgkmcnt(2)
    v_mfma_f32_32x32x16_bf16 v[72:87], v[20:23], v[120:123], 0
    ds_read_b128 v[20:23], v3 offset:43008
    s_add_u32 m0, s24, 147456
    s_add_u32 s80, s25, 180224
    buffer_load_dwordx4 v2, s[64:67], s80 offen offset:0 sc1 lds
    v_exp_f32_e64 v10, v10
    v_mfma_f32_32x32x16_bf16 v[72:87], v[24:27], v[124:127], v[72:87]
    ds_read_b128 v[24:27], v3 offset:44032
    v_mul_f32 v114, v106, v114
    v_exp_f32 v11, v11
    v_mul_f32_e64 v115, v107, v115
    v_fma_f32 v104, v8, v6, v6
    v_mfma_f32_32x32x16_bf16 v[72:87], v[28:31], v[128:131], v[72:87]
    ds_read_b128 v[28:31], v3 offset:45056
    buffer_load_dwordx4 v2, s[64:67], s80 offen offset:1024 sc1 lds
    v_fma_f32 v105, v9, v6, v6
    v_rcp_f32_e64 v104, v104
    v_fma_f32 v106, v10, v6, v6
    v_mfma_f32_32x32x16_bf16 v[72:87], v[32:35], v[132:135], v[72:87]
    ds_read_b128 v[32:35], v3 offset:46080
    v_rcp_f32 v105, v105
    v_fma_f32 v107, v11, v6, v6
    s_waitcnt lgkmcnt(2)
    v_mfma_f32_32x32x16_bf16 v[72:87], v[36:39], v[136:139], v[72:87]
    ds_read_b128 v[36:39], v3 offset:47104
    buffer_load_dwordx4 v2, s[64:67], s80 offen offset:2048 sc1 lds
    v_rcp_f32 v106, v106
    v_mul_f32 v112, v112, v104
    v_mfma_f32_32x32x16_bf16 v[72:87], v[40:43], v[140:143], v[72:87]
    ds_read_b128 v[40:43], v3 offset:48128
    v_rcp_f32 v107, v107
    v_mul_f32 v113, v113, v105
    v_mul_f32 v114, v114, v106
    v_mul_f32 v115, v115, v107
    v_mfma_f32_32x32x16_bf16 v[72:87], v[20:23], v[144:147], v[72:87]
    s_waitcnt vmcnt(13)
    s_barrier
    ds_read_b128 v[20:23], v3 offset:49152
    v_cvt_pk_bf16_f32 v16, v112, v113
    v_mfma_f32_32x32x16_bf16 v[72:87], v[24:27], v[148:151], v[72:87]
    ds_read_b128 v[24:27], v3 offset:50176
    v_cvt_pk_bf16_f32 v17, v114, v115
    v_mul_f32 v8, v108, v108
    v_mul_f32 v9, v109, v109
    v_mul_f32 v10, v110, v110
    s_waitcnt lgkmcnt(2)
    v_mfma_f32_32x32x16_bf16 v[72:87], v[28:31], v[152:155], v[72:87]
    ds_read_b128 v[28:31], v3 offset:51200
    buffer_load_dwordx4 v2, s[64:67], s80 offen offset:3072 sc1 lds
    v_mul_f32_e64 v11, v111, v111
    v_fma_f32 v8, v8, v5, v4
    v_fma_f32 v9, v9, v5, v4
    v_fma_f32 v10, v10, v5, v4
    v_mfma_f32_32x32x16_bf16 v[72:87], v[32:35], v[156:159], v[72:87]
    ds_read_b128 v[32:35], v3 offset:52224
    v_fma_f32 v11, v11, v5, v4
    v_mul_f32 v8, v8, v108
    v_mul_f32 v9, v9, v109
    v_mul_f32 v10, v10, v110
    v_mul_f32 v11, v11, v111
    v_mfma_f32_32x32x16_bf16 v[72:87], v[36:39], v[160:163], v[72:87]
    ds_read_b128 v[36:39], v3 offset:53248
    buffer_load_dwordx4 a[168:171], v14, s[64:67], s34 offen offset:1024 sc1
    v_exp_f32 v8, v8
    v_mul_f32 v116, v108, v116
    v_mfma_f32_32x32x16_bf16 v[72:87], v[40:43], v[164:167], v[72:87]
    ds_read_b128 v[40:43], v3 offset:54272
    v_exp_f32_e64 v9, v9
    v_mul_f32 v117, v109, v117
    s_waitcnt lgkmcnt(2)
    v_mfma_f32_32x32x16_bf16 v[72:87], v[20:23], v[168:171], v[72:87]
    ds_read_b128 v[20:23], v3 offset:55296
    buffer_load_dwordx4 a[172:175], v14, s[64:67], s35 offen offset:1024 sc1
    v_exp_f32 v10, v10
    v_mul_f32 v118, v110, v118
    v_mfma_f32_32x32x16_bf16 v[72:87], v[24:27], v[172:175], v[72:87]
    ds_read_b128 v[24:27], v3 offset:56320
    v_exp_f32 v11, v11
    v_mul_f32 v119, v111, v119
    v_fma_f32 v108, v8, v6, v6
    v_fma_f32 v109, v9, v6, v6
    v_mfma_f32_32x32x16_bf16 v[72:87], v[28:31], v[176:179], v[72:87]
    ds_read_b128 v[28:31], v3 offset:57344
    s_add_u32 m0, s24, 65536
    s_add_u32 s80, s25, 196608
    buffer_load_dwordx4 v2, s[64:67], s80 offen offset:0 sc1 lds
    v_rcp_f32_e64 v108, v108
    v_mfma_f32_32x32x16_bf16 v[72:87], v[32:35], v[180:183], v[72:87]
    ds_read_b128 v[32:35], v3 offset:58368
    v_fma_f32 v110, v10, v6, v6
    v_rcp_f32 v109, v109
    v_fma_f32 v111, v11, v6, v6
    s_waitcnt lgkmcnt(2)
    v_mfma_f32_32x32x16_bf16 v[72:87], v[36:39], v[184:187], v[72:87]
    ds_read_b128 v[36:39], v3 offset:59392
    buffer_load_dwordx4 v2, s[64:67], s80 offen offset:1024 sc1 lds
    v_rcp_f32 v110, v110
    v_mul_f32 v116, v116, v108
    v_mfma_f32_32x32x16_bf16 v[72:87], v[40:43], v[188:191], v[72:87]
    ds_read_b128 v[40:43], v3 offset:60416
    v_rcp_f32 v111, v111
    v_mul_f32 v117, v117, v109
    v_mul_f32 v118, v118, v110
    v_mul_f32 v119, v119, v111
    v_mfma_f32_32x32x16_bf16 v[72:87], v[20:23], v[192:195], v[72:87]
    ds_read_b128 v[20:23], v3 offset:61440
    buffer_load_dwordx4 v2, s[64:67], s80 offen offset:2048 sc1 lds
    v_cvt_pk_bf16_f32 v18, v116, v117
    v_cvt_pk_bf16_f32 v19, v118, v119
    v_mul_f32 v8, v56, v56
    v_mul_f32 v9, v57, v57
    v_mfma_f32_32x32x16_bf16 v[72:87], v[24:27], v[196:199], v[72:87]
    ds_read_b128 v[24:27], v3 offset:62464
    v_mul_f32_e64 v10, v58, v58
    v_mul_f32 v11, v59, v59
    v_fma_f32 v8, v8, v5, v4
    v_fma_f32 v9, v9, v5, v4
    s_waitcnt lgkmcnt(2)
    v_mfma_f32_32x32x16_bf16 v[72:87], v[28:31], v[200:203], v[72:87]
    ds_read_b128 v[28:31], v3 offset:63488
    buffer_load_dwordx4 v2, s[64:67], s80 offen offset:3072 sc1 lds
    v_fma_f32 v10, v10, v5, v4
    v_fma_f32 v11, v11, v5, v4
    v_mul_f32 v8, v8, v56
    v_mul_f32 v9, v9, v57
    v_mfma_f32_32x32x16_bf16 v[72:87], v[32:35], v[204:207], v[72:87]
    ds_read_b128 v[32:35], v3 offset:64512
    s_waitcnt vmcnt(10)
    s_mov_b64 exec, 1
    buffer_store_dword v251, v2, s[64:67], s12 offen offset:0 sc1
    s_mov_b64 exec, -1
    v_mul_f32_e64 v10, v10, v58
    v_mfma_f32_32x32x16_bf16 v[72:87], v[36:39], v[208:211], v[72:87]
    s_barrier
    ds_read_b128 v[36:39], v7 offset:0
    buffer_store_dwordx4 v[16:19], v2, s[64:67], s10 offen offset:2048 sc1
    v_mfma_f32_32x32x16_bf16 v[72:87], v[40:43], v[212:215], v[72:87]
    ds_read_b128 v[40:43], v7 offset:1024
    v_mul_f32 v11, v11, v59
    v_exp_f32 v8, v8
    v_mul_f32 v64, v56, v64
    s_waitcnt lgkmcnt(2)
    v_mfma_f32_32x32x16_bf16 v[72:87], v[20:23], v[216:219], v[72:87]
    ds_read_b128 v[20:23], v7 offset:2048
    v_exp_f32 v9, v9
    v_mul_f32 v65, v57, v65
    v_exp_f32_e64 v10, v10
    v_mfma_f32_32x32x16_bf16 v[72:87], v[24:27], v[220:223], v[72:87]
    ds_read_b128 v[24:27], v7 offset:3072
    v_mul_f32 v66, v58, v66
    v_exp_f32 v11, v11
    v_mul_f32_e64 v67, v59, v67
    v_fma_f32 v56, v8, v6, v6
    v_mfma_f32_32x32x16_bf16 v[72:87], v[28:31], v[224:227], v[72:87]
    ds_read_b32 v28, v250 offset:4096
    ds_read_b32 v29, v250 offset:4224
    ds_read_b32 v30, v250 offset:4352
    ds_read_b32 v31, v250 offset:4480
    v_fma_f32 v57, v9, v6, v6
    v_mfma_f32_32x32x16_bf16 v[72:87], v[32:35], v[228:231], v[72:87]
    ds_read_b128 v[32:35], v7 offset:5120
    buffer_load_dwordx4 a[176:179], v14, s[64:67], s34 offen offset:2048 sc1
    v_rcp_f32 v56, v56
    v_fma_f32 v58, v10, v6, v6
    s_waitcnt lgkmcnt(5)
    v_mfma_f32_32x32x16_bf16 v[72:87], v[36:39], v[232:235], v[72:87]
    ds_read_b128 v[36:39], v7 offset:6144
    v_rcp_f32_e64 v57, v57
    v_fma_f32 v59, v11, v6, v6
    v_rcp_f32_e64 v58, v58
    v_mfma_f32_32x32x16_bf16 v[72:87], v[40:43], v[236:239], v[72:87]
    ds_read_b128 v[40:43], v7 offset:7168
    buffer_load_dwordx4 a[180:183], v14, s[64:67], s35 offen offset:2048 sc1
    v_mul_f32 v64, v64, v56
    v_rcp_f32 v59, v59
    v_mul_f32_e64 v65, v65, v57
    v_mfma_f32_32x32x16_bf16 v[72:87], v[20:23], v[240:243], v[72:87]
    ds_read_b128 v[20:23], v7 offset:8192
    v_mul_f32 v66, v66, v58
    v_mul_f32 v67, v67, v59
    v_cvt_pk_bf16_f32 v16, v64, v65
    v_cvt_pk_bf16_f32 v17, v66, v67
    v_mul_f32_e64 v8, v60, v60
    v_mfma_f32_32x32x16_bf16 v[72:87], v[24:27], v[244:247], v[72:87]
    ds_read_b128 v[24:27], v7 offset:9216
    s_add_u32 m0, s24, 81920
    s_add_u32 s80, s25, 212992
    buffer_load_dwordx4 v2, s[64:67], s80 offen offset:0 sc1 lds
    v_mul_f32 v9, v61, v61
    s_waitcnt lgkmcnt(2)
    v_mfma_f32_32x32x16_bf16 v[72:87], v[28:31], v[44:47], v[72:87]
    ds_read_b128 v[28:31], v7 offset:10240
    v_mul_f32 v10, v62, v62
    v_mul_f32 v11, v63, v63
    v_fma_f32 v8, v8, v5, v4
    v_fma_f32 v9, v9, v5, v4
    v_fma_f32 v10, v10, v5, v4
    v_mfma_f32_32x32x16_bf16 v[88:103], v[32:35], v[120:123], 0
    ds_read_b128 v[32:35], v7 offset:11264
    buffer_load_dwordx4 v2, s[64:67], s80 offen offset:1024 sc1 lds
    v_fma_f32 v11, v11, v5, v4
    v_mul_f32 v8, v8, v60
    v_mul_f32 v9, v9, v61
    v_mul_f32_e64 v10, v10, v62
    v_mfma_f32_32x32x16_bf16 v[88:103], v[36:39], v[124:127], v[88:103]
    ds_read_b128 v[36:39], v7 offset:12288
    v_mul_f32 v11, v11, v63
    v_exp_f32 v8, v8
    v_mul_f32_e64 v68, v60, v68
    v_mfma_f32_32x32x16_bf16 v[88:103], v[40:43], v[128:131], v[88:103]
    ds_read_b128 v[40:43], v7 offset:13312
    buffer_load_dwordx4 v2, s[64:67], s80 offen offset:2048 sc1 lds
    v_exp_f32_e64 v9, v9
    v_mul_f32 v69, v61, v69
    s_waitcnt lgkmcnt(2)
    v_mfma_f32_32x32x16_bf16 v[88:103], v[20:23], v[132:135], v[88:103]
    ds_read_b128 v[20:23], v7 offset:14336
    v_exp_f32 v10, v10
    v_mul_f32 v70, v62, v70
    v_exp_f32_e64 v11, v11
    v_mfma_f32_32x32x16_bf16 v[88:103], v[24:27], v[136:139], v[88:103]
    ds_read_b128 v[24:27], v7 offset:15360
    buffer_load_dwordx4 v2, s[64:67], s80 offen offset:3072 sc1 lds
    v_mul_f32_e64 v71, v63, v71
    v_fma_f32 v60, v8, v6, v6
    v_fma_f32 v61, v9, v6, v6
    v_mfma_f32_32x32x16_bf16 v[88:103], v[28:31], v[140:143], v[88:103]
    s_waitcnt vmcnt(14)
    s_barrier
    ds_read_b128 v[28:31], v7 offset:16384
    v_mfma_f32_32x32x16_bf16 v[88:103], v[32:35], v[144:147], v[88:103]
    ds_read_b128 v[32:35], v7 offset:17408
    v_rcp_f32 v60, v60
    v_fma_f32 v62, v10, v6, v6
    s_waitcnt lgkmcnt(2)
    v_mfma_f32_32x32x16_bf16 v[88:103], v[36:39], v[148:151], v[88:103]
    ds_read_b128 v[36:39], v7 offset:18432
    buffer_load_dwordx4 a[184:187], v14, s[64:67], s34 offen offset:3072 sc1
    v_rcp_f32_e64 v61, v61
    v_fma_f32 v63, v11, v6, v6
    v_mfma_f32_32x32x16_bf16 v[88:103], v[40:43], v[152:155], v[88:103]
    ds_read_b128 v[40:43], v7 offset:19456
    v_rcp_f32 v62, v62
    v_mul_f32 v68, v68, v60
    v_rcp_f32_e64 v63, v63
    v_mfma_f32_32x32x16_bf16 v[88:103], v[20:23], v[156:159], v[88:103]
    ds_read_b128 v[20:23], v7 offset:20480
    buffer_load_dwordx4 a[188:191], v14, s[64:67], s35 offen offset:3072 sc1
    v_mul_f32 v69, v69, v61
    v_mul_f32 v70, v70, v62
    v_mul_f32_e64 v71, v71, v63
    v_cvt_pk_bf16_f32 v18, v68, v69
    v_mfma_f32_32x32x16_bf16 v[88:103], v[24:27], v[160:163], v[88:103]
    ds_read_b128 v[24:27], v7 offset:21504
    v_cvt_pk_bf16_f32 v19, v70, v71
    buffer_store_dwordx4 v[16:19], v2, s[64:67], s10 offen offset:3072 sc1
    s_add_u32 s10, s10, 4096
    v_mul_f32 v8, v72, v72
    s_waitcnt lgkmcnt(2)
    v_mfma_f32_32x32x16_bf16 v[88:103], v[28:31], v[164:167], v[88:103]
    ds_read_b128 v[28:31], v7 offset:22528
    v_mul_f32 v9, v73, v73
    v_mul_f32 v10, v74, v74
    v_mul_f32_e64 v11, v75, v75
    v_fma_f32 v8, v8, v5, v4
    v_fma_f32 v9, v9, v5, v4
    v_mfma_f32_32x32x16_bf16 v[88:103], v[32:35], v[168:171], v[88:103]
    ds_read_b128 v[32:35], v7 offset:23552
    v_fma_f32 v10, v10, v5, v4
    v_fma_f32 v11, v11, v5, v4
    v_mul_f32 v8, v8, v72
    v_mul_f32 v9, v9, v73
    v_mul_f32_e64 v10, v10, v74
    v_mfma_f32_32x32x16_bf16 v[88:103], v[36:39], v[172:175], v[88:103]
    ds_read_b128 v[36:39], v7 offset:24576
    v_mul_f32 v11, v11, v75
    v_exp_f32 v8, v8
    v_mul_f32_e64 v80, v72, v80
    v_mfma_f32_32x32x16_bf16 v[88:103], v[40:43], v[176:179], v[88:103]
    ds_read_b128 v[40:43], v7 offset:25600
    v_exp_f32_e64 v9, v9
    v_mul_f32 v81, v73, v81
    s_waitcnt lgkmcnt(2)
    v_mfma_f32_32x32x16_bf16 v[88:103], v[20:23], v[180:183], v[88:103]
    ds_read_b128 v[20:23], v7 offset:26624
    s_add_u32 m0, s22, 98304
    s_add_u32 s80, s23, 229376
    buffer_load_dwordx4 v2, s[64:67], s80 offen offset:0 sc1 lds
    v_exp_f32_e64 v10, v10
    v_mfma_f32_32x32x16_bf16 v[88:103], v[24:27], v[184:187], v[88:103]
    ds_read_b128 v[24:27], v7 offset:27648
    v_mul_f32 v82, v74, v82
    v_exp_f32 v11, v11
    v_mul_f32_e64 v83, v75, v83
    v_fma_f32 v72, v8, v6, v6
    v_mfma_f32_32x32x16_bf16 v[88:103], v[28:31], v[188:191], v[88:103]
    ds_read_b128 v[28:31], v7 offset:28672
    buffer_load_dwordx4 v2, s[64:67], s80 offen offset:1024 sc1 lds
    v_fma_f32 v73, v9, v6, v6
    v_rcp_f32_e64 v72, v72
    v_fma_f32 v74, v10, v6, v6
    v_mfma_f32_32x32x16_bf16 v[88:103], v[32:35], v[192:195], v[88:103]
    ds_read_b128 v[32:35], v7 offset:29696
    v_rcp_f32 v73, v73
    v_fma_f32 v75, v11, v6, v6
    s_waitcnt lgkmcnt(2)
    v_mfma_f32_32x32x16_bf16 v[88:103], v[36:39], v[196:199], v[88:103]
    ds_read_b128 v[36:39], v7 offset:30720
    s_add_u32 s34, s16, 24576
    buffer_load_dwordx4 a[192:195], v14, s[64:67], s34 offen offset:0 sc1
    v_rcp_f32 v74, v74
    v_mul_f32 v80, v80, v72
    v_mfma_f32_32x32x16_bf16 v[88:103], v[40:43], v[200:203], v[88:103]
    ds_read_b128 v[40:43], v7 offset:31744
    v_rcp_f32 v75, v75
    v_mul_f32 v81, v81, v73
    v_mul_f32 v82, v82, v74
    v_mul_f32 v83, v83, v75
    v_mfma_f32_32x32x16_bf16 v[88:103], v[20:23], v[204:207], v[88:103]
    s_waitcnt vmcnt(14)
    s_barrier
    ds_read_b128 v[20:23], v3 offset:0
    v_cvt_pk_bf16_f32 v16, v80, v81
    v_mfma_f32_32x32x16_bf16 v[88:103], v[24:27], v[208:211], v[88:103]
    ds_read_b128 v[24:27], v3 offset:1024
    v_cvt_pk_bf16_f32 v17, v82, v83
    v_mul_f32 v8, v76, v76
    v_mul_f32 v9, v77, v77
    v_mul_f32 v10, v78, v78
    s_waitcnt lgkmcnt(2)
    v_mfma_f32_32x32x16_bf16 v[88:103], v[28:31], v[212:215], v[88:103]
    ds_read_b128 v[28:31], v3 offset:2048
    s_add_u32 s35, s17, 24576
    buffer_load_dwordx4 a[196:199], v14, s[64:67], s35 offen offset:0 sc1
    v_mul_f32_e64 v11, v79, v79
    v_fma_f32 v8, v8, v5, v4
    v_fma_f32 v9, v9, v5, v4
    v_mfma_f32_32x32x16_bf16 v[88:103], v[32:35], v[216:219], v[88:103]
    ds_read_b128 v[32:35], v3 offset:3072
    v_fma_f32 v10, v10, v5, v4
    v_fma_f32 v11, v11, v5, v4
    v_mul_f32 v8, v8, v76
    v_mul_f32 v9, v9, v77
    v_mul_f32_e64 v10, v10, v78
    v_mfma_f32_32x32x16_bf16 v[88:103], v[36:39], v[220:223], v[88:103]
    ds_read_b128 v[36:39], v3 offset:4096
    buffer_load_dword v252, v254, s[64:67], s13 offen offset:0 sc1
    v_mul_f32 v11, v11, v79
    v_exp_f32 v8, v8
    v_mul_f32_e64 v84, v76, v84
    v_mfma_f32_32x32x16_bf16 v[88:103], v[40:43], v[224:227], v[88:103]
    ds_read_b32 v40, v249 offset:5120
    ds_read_b32 v41, v249 offset:5248
    ds_read_b32 v42, v249 offset:5376
    ds_read_b32 v43, v249 offset:5504
    s_waitcnt lgkmcnt(5)
    v_mfma_f32_32x32x16_bf16 v[88:103], v[20:23], v[228:231], v[88:103]
    ds_read_b128 v[20:23], v3 offset:6144
    buffer_load_dwordx4 a[200:203], v14, s[64:67], s34 offen offset:1024 sc1
    v_exp_f32 v9, v9
    v_mul_f32_e64 v85, v77, v85
    v_mfma_f32_32x32x16_bf16 v[88:103], v[24:27], v[232:235], v[88:103]
    ds_read_b128 v[24:27], v3 offset:7168
    buffer_load_dwordx4 a[204:207], v14, s[64:67], s35 offen offset:1024 sc1
    v_exp_f32 v10, v10
    v_mul_f32 v86, v78, v86
    v_mfma_f32_32x32x16_bf16 v[88:103], v[28:31], v[236:239], v[88:103]
    ds_read_b128 v[28:31], v3 offset:8192
    v_exp_f32 v11, v11
    v_mul_f32 v87, v79, v87
    v_fma_f32 v76, v8, v6, v6
    v_fma_f32 v77, v9, v6, v6
    v_mfma_f32_32x32x16_bf16 v[88:103], v[32:35], v[240:243], v[88:103]
    ds_read_b128 v[32:35], v3 offset:9216
    buffer_load_dwordx4 a[208:211], v14, s[64:67], s34 offen offset:2048 sc1
    v_rcp_f32 v76, v76
    v_fma_f32 v78, v10, v6, v6
    s_waitcnt lgkmcnt(2)
    v_mfma_f32_32x32x16_bf16 v[88:103], v[36:39], v[244:247], v[88:103]
    ds_read_b128 v[36:39], v3 offset:10240
    v_rcp_f32_e64 v77, v77
    v_fma_f32 v79, v11, v6, v6
    v_rcp_f32_e64 v78, v78
    v_mfma_f32_32x32x16_bf16 v[88:103], v[40:43], v[44:47], v[88:103]
    ds_read_b128 v[40:43], v3 offset:11264
    buffer_load_dwordx4 a[212:215], v14, s[64:67], s35 offen offset:2048 sc1
    v_mul_f32 v84, v84, v76
    v_rcp_f32 v79, v79
    v_mul_f32_e64 v85, v85, v77
    v_mfma_f32_32x32x16_bf16 v[104:119], v[20:23], v[120:123], 0
    ds_read_b128 v[20:23], v3 offset:12288
    v_mul_f32 v86, v86, v78
    v_mul_f32 v87, v87, v79
    v_cvt_pk_bf16_f32 v18, v84, v85
    v_cvt_pk_bf16_f32 v19, v86, v87
    buffer_store_dwordx4 v[16:19], v2, s[64:67], s10 offen offset:0 sc1
    v_mfma_f32_32x32x16_bf16 v[104:119], v[24:27], v[124:127], v[104:119]
    ds_read_b128 v[24:27], v3 offset:13312
    s_waitcnt lgkmcnt(2)
    v_mfma_f32_32x32x16_bf16 v[104:119], v[28:31], v[128:131], v[104:119]
    ds_read_b128 v[28:31], v3 offset:14336
    v_mul_f32 v8, v88, v88
    v_mul_f32 v9, v89, v89
    v_mul_f32 v10, v90, v90
    v_mul_f32_e64 v11, v91, v91
    v_fma_f32 v8, v8, v5, v4
    v_mfma_f32_32x32x16_bf16 v[104:119], v[32:35], v[132:135], v[104:119]
    ds_read_b128 v[32:35], v3 offset:15360
    s_waitcnt vmcnt(10)
    s_mov_b64 exec, 1
    buffer_store_dword v251, v2, s[64:67], s12 offen offset:128 sc1
    s_mov_b64 exec, -1
    v_fma_f32 v9, v9, v5, v4
    v_mfma_f32_32x32x16_bf16 v[104:119], v[36:39], v[136:139], v[104:119]
    s_barrier
    ds_read_b128 v[36:39], v3 offset:16384
    v_fma_f32 v10, v10, v5, v4
    v_mfma_f32_32x32x16_bf16 v[104:119], v[40:43], v[140:143], v[104:119]
    ds_read_b128 v[40:43], v3 offset:17408
    v_fma_f32 v11, v11, v5, v4
    v_mul_f32 v8, v8, v88
    v_mul_f32 v9, v9, v89
    v_mul_f32 v10, v10, v90
    s_waitcnt lgkmcnt(2)
    v_mfma_f32_32x32x16_bf16 v[104:119], v[20:23], v[144:147], v[104:119]
    ds_read_b128 v[20:23], v3 offset:18432
    buffer_load_dwordx4 a[216:219], v14, s[64:67], s34 offen offset:3072 sc1
    v_mul_f32 v11, v11, v91
    v_exp_f32 v8, v8
    v_mul_f32_e64 v96, v88, v96
    v_mfma_f32_32x32x16_bf16 v[104:119], v[24:27], v[148:151], v[104:119]
    ds_read_b128 v[24:27], v3 offset:19456
    v_exp_f32 v9, v9
    v_mul_f32 v97, v89, v97
    v_exp_f32_e64 v10, v10
    v_mfma_f32_32x32x16_bf16 v[104:119], v[28:31], v[152:155], v[104:119]
    ds_read_b128 v[28:31], v3 offset:20480
    buffer_load_dwordx4 a[220:223], v14, s[64:67], s35 offen offset:3072 sc1
    v_mul_f32 v98, v90, v98
    v_exp_f32 v11, v11
    v_mul_f32_e64 v99, v91, v99
    v_mfma_f32_32x32x16_bf16 v[104:119], v[32:35], v[156:159], v[104:119]
    ds_read_b128 v[32:35], v3 offset:21504
    v_fma_f32 v88, v8, v6, v6
    v_fma_f32 v89, v9, v6, v6
    v_rcp_f32 v88, v88
    s_waitcnt lgkmcnt(2)
    v_mfma_f32_32x32x16_bf16 v[104:119], v[36:39], v[160:163], v[104:119]
    ds_read_b128 v[36:39], v3 offset:22528
    v_fma_f32 v90, v10, v6, v6
    v_rcp_f32_e64 v89, v89
    v_fma_f32 v91, v11, v6, v6
    v_mfma_f32_32x32x16_bf16 v[104:119], v[40:43], v[164:167], v[104:119]
    ds_read_b128 v[40:43], v3 offset:23552
    v_rcp_f32 v90, v90
    v_mul_f32 v96, v96, v88
    v_rcp_f32_e64 v91, v91
    v_mfma_f32_32x32x16_bf16 v[104:119], v[20:23], v[168:171], v[104:119]
    ds_read_b128 v[20:23], v3 offset:24576
    v_mul_f32 v97, v97, v89
    v_mul_f32 v98, v98, v90
    v_mul_f32_e64 v99, v99, v91
    v_cvt_pk_bf16_f32 v16, v96, v97
    v_cvt_pk_bf16_f32 v17, v98, v99
    v_mfma_f32_32x32x16_bf16 v[104:119], v[24:27], v[172:175], v[104:119]
    ds_read_b128 v[24:27], v3 offset:25600
    v_mul_f32 v8, v92, v92
    v_mul_f32 v9, v93, v93
    v_mul_f32_e64 v10, v94, v94
    v_mul_f32 v11, v95, v95
    s_waitcnt lgkmcnt(2)
    v_mfma_f32_32x32x16_bf16 v[104:119], v[28:31], v[176:179], v[104:119]
    ds_read_b128 v[28:31], v3 offset:26624
L_p0_chk:
    s_waitcnt vmcnt(8)
    v_cmp_ne_u32 vcc, v251, v252
    s_nop 0
    s_cbranch_vccnz L_p0_retry
L_p0_ok:
    v_fma_f32 v8, v8, v5, v4
    v_fma_f32 v9, v9, v5, v4
    v_mfma_f32_32x32x16_bf16 v[104:119], v[32:35], v[180:183], v[104:119]
    ds_read_b128 v[32:35], v3 offset:27648
    s_add_u32 s36, s14, 0
    buffer_load_dwordx4 v[120:123], v2, s[64:67], s36 offen offset:0 sc1
    v_fma_f32 v10, v10, v5, v4
    v_fma_f32 v11, v11, v5, v4
    v_mul_f32 v8, v8, v92
    v_mfma_f32_32x32x16_bf16 v[104:119], v[36:39], v[184:187], v[104:119]
    ds_read_b128 v[36:39], v3 offset:28672
L_touch4:
    s_cbranch_execz L_touched
    s_nop 0
    s_add_u32 s37, s14, 114688
    buffer_load_dwordx4 v[124:127], v2, s[64:67], s37 offen offset:0 sc1
    v_mul_f32 v9, v9, v93
    v_mul_f32 v10, v10, v94
    v_mul_f32_e64 v11, v11, v95
    v_mfma_f32_32x32x16_bf16 v[104:119], v[40:43], v[188:191], v[104:119]
    ds_read_b128 v[40:43], v3 offset:29696
    v_exp_f32_e64 v8, v8
    v_mul_f32 v100, v92, v100
    s_waitcnt lgkmcnt(2)
    v_mfma_f32_32x32x16_bf16 v[104:119], v[20:23], v[192:195], v[104:119]
    ds_read_b128 v[20:23], v3 offset:30720
    buffer_load_dwordx4 v[128:131], v2, s[64:67], s36 offen offset:1024 sc1
    v_exp_f32 v9, v9
    v_mul_f32 v101, v93, v101
    v_mfma_f32_32x32x16_bf16 v[104:119], v[24:27], v[196:199], v[104:119]
    ds_read_b128 v[24:27], v3 offset:31744
    v_exp_f32 v10, v10
    v_mul_f32 v102, v94, v102
    v_exp_f32 v11, v11
    v_mfma_f32_32x32x16_bf16 v[104:119], v[28:31], v[200:203], v[104:119]
    s_barrier
    ds_read_b128 v[28:31], v3 offset:32768
    v_mul_f32_e64 v103, v95, v103
    v_mfma_f32_32x32x16_bf16 v[104:119], v[32:35], v[204:207], v[104:119]
    ds_read_b128 v[32:35], v3 offset:33792
    v_fma_f32 v92, v8, v6, v6
    v_fma_f32 v93, v9, v6, v6
    v_rcp_f32 v92, v92
    s_waitcnt lgkmcnt(2)
    v_mfma_f32_32x32x16_bf16 v[104:119], v[36:39], v[208:211], v[104:119]
    ds_read_b128 v[36:39], v3 offset:34816
    buffer_load_dwordx4 v[132:135], v2, s[64:67], s37 offen offset:1024 sc1
    v_fma_f32 v94, v10, v6, v6
    v_rcp_f32_e64 v93, v93
    v_fma_f32 v95, v11, v6, v6
    v_mfma_f32_32x32x16_bf16 v[104:119], v[40:43], v[212:215], v[104:119]
    ds_read_b128 v[40:43], v3 offset:35840
    v_rcp_f32 v94, v94
    v_mul_f32 v100, v100, v92
    v_rcp_f32_e64 v95, v95
    v_mfma_f32_32x32x16_bf16 v[104:119], v[20:23], v[216:219], v[104:119]
    ds_read_b128 v[20:23], v3 offset:36864
    s_add_u32 s36, s14, 7168
    buffer_load_dwordx4 v[136:139], v2, s[64:67], s36 offen offset:0 sc1
    v_mul_f32 v101, v101, v93
    v_mul_f32 v102, v102, v94
    v_mul_f32 v103, v103, v95
    v_mfma_f32_32x32x16_bf16 v[104:119], v[24:27], v[220:223], v[104:119]
    ds_read_b128 v[24:27], v3 offset:37888
    v_cvt_pk_bf16_f32 v18, v100, v101
    v_cvt_pk_bf16_f32 v19, v102, v103
    buffer_store_dwordx4 v[16:19], v2, s[64:67], s10 offen offset:1024 sc1
    s_waitcnt lgkmcnt(2)
    v_mfma_f32_32x32x16_bf16 v[104:119], v[28:31], v[224:227], v[104:119]
    ds_read_b32 v28, v249 offset:38912
    ds_read_b32 v29, v249 offset:39040
    ds_read_b32 v30, v249 offset:39168
    ds_read_b32 v31, v249 offset:39296
    v_mfma_f32_32x32x16_bf16 v[104:119], v[32:35], v[228:231], v[104:119]
    s_waitcnt vmcnt(9)
    s_mov_b64 exec, 1
    buffer_store_dword v251, v2, s[64:67], s12 offen offset:256 sc1
    s_mov_b64 exec, -1
    v_mfma_f32_32x32x16_bf16 v[104:119], v[36:39], v[232:235], v[104:119]
    v_mfma_f32_32x32x16_bf16 v[104:119], v[40:43], v[236:239], v[104:119]
    s_waitcnt lgkmcnt(0)
    v_mfma_f32_32x32x16_bf16 v[104:119], v[20:23], v[240:243], v[104:119]
    s_add_u32 s37, s14, 121856
    buffer_load_dwordx4 v[140:143], v2, s[64:67], s37 offen offset:0 sc1
    v_mfma_f32_32x32x16_bf16 v[104:119], v[24:27], v[244:247], v[104:119]
    v_mfma_f32_32x32x16_bf16 v[104:119], v[28:31], v[44:47], v[104:119]
    buffer_load_dwordx4 v[144:147], v2, s[64:67], s36 offen offset:1024 sc1
    buffer_load_dwordx4 v[148:151], v2, s[64:67], s37 offen offset:1024 sc1
    s_nop 9
    v_mul_f32 v8, v104, v104
    v_mul_f32 v9, v105, v105
    v_mul_f32 v10, v106, v106
    v_mul_f32_e64 v11, v107, v107
    v_fma_f32 v8, v8, v5, v4
    v_fma_f32 v9, v9, v5, v4
    v_fma_f32 v10, v10, v5, v4
    v_fma_f32 v11, v11, v5, v4
    v_mul_f32 v8, v8, v104
    v_mul_f32 v9, v9, v105
    v_mul_f32 v10, v10, v106
    v_mul_f32 v11, v11, v107
    v_exp_f32 v8, v8
    v_mul_f32 v112, v104, v112
    v_exp_f32 v9, v9
    v_mul_f32 v113, v105, v113
    v_exp_f32 v10, v10
    v_mul_f32 v114, v106, v114
    v_exp_f32 v11, v11
    v_mul_f32 v115, v107, v115
    v_fma_f32 v104, v8, v6, v6
    v_fma_f32 v105, v9, v6, v6
    v_rcp_f32_e64 v104, v104
    s_add_u32 s36, s14, 14336
    buffer_load_dwordx4 v[152:155], v2, s[64:67], s36 offen offset:0 sc1
    v_fma_f32 v106, v10, v6, v6
    v_rcp_f32_e64 v105, v105
    v_fma_f32 v107, v11, v6, v6
    v_rcp_f32 v106, v106
    v_mul_f32 v112, v112, v104
    v_rcp_f32 v107, v107
    v_mul_f32 v113, v113, v105
    v_mul_f32 v114, v114, v106
    v_mul_f32 v115, v115, v107
    v_cvt_pk_bf16_f32 v16, v112, v113
    v_cvt_pk_bf16_f32 v17, v114, v115
    v_mul_f32 v8, v108, v108
    v_mul_f32 v9, v109, v109
    v_mul_f32 v10, v110, v110
    v_mul_f32 v11, v111, v111
    v_fma_f32 v8, v8, v5, v4
    v_fma_f32 v9, v9, v5, v4
    v_fma_f32 v10, v10, v5, v4
    v_fma_f32 v11, v11, v5, v4
    v_mul_f32 v8, v8, v108
    v_mul_f32 v9, v9, v109
    v_mul_f32 v10, v10, v110
    v_mul_f32 v11, v11, v111
    s_add_u32 s37, s14, 129024
    buffer_load_dwordx4 v[156:159], v2, s[64:67], s37 offen offset:0 sc1
    v_exp_f32 v8, v8
    v_mul_f32 v116, v108, v116
    v_exp_f32 v9, v9
    v_mul_f32 v117, v109, v117
    v_exp_f32 v10, v10
    v_mul_f32 v118, v110, v118
    v_exp_f32 v11, v11
    v_mul_f32 v119, v111, v119
    v_fma_f32 v108, v8, v6, v6
    v_fma_f32 v109, v9, v6, v6
    v_rcp_f32_e64 v108, v108
    v_fma_f32 v110, v10, v6, v6
    v_rcp_f32_e64 v109, v109
    v_fma_f32 v111, v11, v6, v6
    v_rcp_f32 v110, v110
    v_mul_f32 v116, v116, v108
    v_rcp_f32 v111, v111
    v_mul_f32 v117, v117, v109
    v_mul_f32 v118, v118, v110
    v_mul_f32 v119, v119, v111
    v_cvt_pk_bf16_f32 v18, v116, v117
    v_cvt_pk_bf16_f32 v19, v118, v119
    buffer_store_dwordx4 v[16:19], v2, s[64:67], s10 offen offset:2048 sc1
    s_buffer_load_dwordx8 s[44:51], s[64:67], s13 offset:128 glc
    buffer_load_dwordx4 v[160:163], v2, s[64:67], s36 offen offset:1024 sc1
    buffer_load_dwordx4 v[164:167], v2, s[64:67], s37 offen offset:1024 sc1
    s_waitcnt vmcnt(14)
    v_mfma_f32_32x32x16_bf16 v[184:199], a[0:3], v[120:123], 0
    v_mfma_f32_32x32x16_bf16 v[200:215], a[4:7], v[120:123], 0
    s_add_u32 s36, s14, 21504
    buffer_load_dwordx4 v[168:171], v2, s[64:67], s36 offen offset:0 sc1
    v_lshrrev_b32 v79, 5, v1
    v_lshlrev_b32_e64 v79, 6, v79
    v_xor_b32 v79, v79, v2
    s_waitcnt vmcnt(14)
    v_mfma_f32_32x32x16_bf16 v[216:231], a[0:3], v[124:127], 0
    v_add_u32_e64 v76, s11, v79
    v_xor_b32 v77, 128, v76
    s_lshr_b32 s81, s75, 1
    s_lshl_b32 s81, s81, 7
    v_xor_b32 v79, s81, v79
    s_lshl_b32 s81, s75, 11
    v_mfma_f32_32x32x16_bf16 v[232:247], a[4:7], v[124:127], 0
    s_add_u32 s37, s14, 136192
    buffer_load_dwordx4 v[172:175], v2, s[64:67], s37 offen offset:0 sc1
    s_add_u32 s81, s81, 114688
    v_add_u32_e64 v74, s81, v79
    v_lshrrev_b32 v75, 3, v1
    s_waitcnt vmcnt(14)
    v_mfma_f32_32x32x16_bf16 v[184:199], a[8:11], v[128:131], v[184:199]
    s_lshl_b32 s81, s75, 3
    v_add_u32 v75, s81, v75
    v_and_b32 v78, 3, v1
    v_lshlrev_b32 v78, 2, v78
    v_xor_b32 v72, v78, v75
    v_and_b32 v78, 1, v1
    v_mfma_f32_32x32x16_bf16 v[200:215], a[12:15], v[128:131], v[200:215]
    buffer_load_dwordx4 v[176:179], v2, s[64:67], s36 offen offset:1024 sc1
    v_lshl_add_u32 v72, v78, 5, v72
    v_bfe_u32 v78, v1, 2, 1
    v_lshl_add_u32 v72, v78, 7, v72
    v_and_b32 v78, 2, v1
    s_waitcnt vmcnt(14)
    v_mfma_f32_32x32x16_bf16 v[216:231], a[8:11], v[132:135], v[216:231]
    v_lshl_add_u32 v72, v78, 7, v72
    v_lshlrev_b32_e64 v72, 4, v72
    v_add_u32 v73, 114688, v72
    v_and_b32 v78, 7, v1
    v_lshlrev_b32 v75, 10, v75
    v_lshl_add_u32 v75, v78, 4, v75
    v_mfma_f32_32x32x16_bf16 v[232:247], a[12:15], v[132:135], v[232:247]
    buffer_load_dwordx4 v[180:183], v2, s[64:67], s37 offen offset:1024 sc1
    v_lshlrev_b32_e64 v78, 5, v78
    s_lshr_b32 s80, s19, 2
    s_lshl_b32 s82, s18, 8
    s_add_u32 s82, s82, s80
    s_waitcnt vmcnt(14)
    v_mfma_f32_32x32x16_bf16 v[184:199], a[56:59], v[136:139], v[184:199]
    s_lshl_b32 s82, s82, 7
    s_add_u32 s83, s82, 32768
    s_lshl_b32 s80, s80, 8
    s_add_u32 s80, s80, 4096
    v_lshrrev_b32_e64 v12, 3, v1
    v_xor_b32 v13, s18, v12
    v_mfma_f32_32x32x16_bf16 v[200:215], a[60:63], v[136:139], v[200:215]
L_p1_chk:
    s_waitcnt lgkmcnt(0)
    s_xor_b64 s[44:45], s[44:45], s[52:53]
    s_xor_b64 s[46:47], s[46:47], s[52:53]
    s_xor_b64 s[48:49], s[48:49], s[52:53]
    s_xor_b64 s[50:51], s[50:51], s[52:53]
    s_or_b64 s[44:45], s[44:45], s[46:47]
    s_or_b64 s[48:49], s[48:49], s[50:51]
    s_or_b64 s[44:45], s[44:45], s[48:49]
    s_cbranch_scc1 L_p1_retry
L_p1_ok:
    s_add_u32 s36, s14, 2048
    buffer_load_dwordx4 v[120:123], v2, s[64:67], s36 offen offset:0 sc1
    v_mul_u32_u24 v12, 96, v12
    v_add_u32_e64 v12, v12, v13
    v_and_b32 v13, 7, v1
    s_waitcnt vmcnt(12)
    v_mfma_f32_32x32x16_bf16 v[216:231], a[56:59], v[140:143], v[216:231]
    v_lshl_add_u32 v13, v12, 3, v13
    v_lshlrev_b32_e64 v13, 4, v13
    v_xor_b32 v12, 128, v13
    s_mul_i32 s81, s19, 98304
    s_add_u32 s81, s81, 1048576
    s_add_u32 m0, s11, 0
    v_mfma_f32_32x32x16_bf16 v[232:247], a[60:63], v[140:143], v[232:247]
    s_add_u32 s37, s14, 116736
    buffer_load_dwordx4 v[124:127], v2, s[64:67], s37 offen offset:0 sc1
    s_sub_u32 s84, s81, 1024
    s_waitcnt vmcnt(12)
    v_mfma_f32_32x32x16_bf16 v[184:199], a[64:67], v[144:147], v[184:199]
    v_mfma_f32_32x32x16_bf16 v[200:215], a[68:71], v[144:147], v[200:215]
    buffer_load_dwordx4 v[128:131], v2, s[64:67], s36 offen offset:1024 sc1
    s_waitcnt vmcnt(12)
    v_mfma_f32_32x32x16_bf16 v[216:231], a[64:67], v[148:151], v[216:231]
    v_mfma_f32_32x32x16_bf16 v[232:247], a[68:71], v[148:151], v[232:247]
    s_waitcnt vmcnt(9)
    s_mov_b64 exec, 1
    buffer_store_dword v251, v2, s[64:67], s12 offen offset:384 sc1
    s_mov_b64 exec, -1
    buffer_load_dwordx4 v[132:135], v2, s[64:67], s37 offen offset:1024 sc1
    v_mfma_f32_32x32x16_bf16 v[184:199], a[112:115], v[152:155], v[184:199]
    v_mfma_f32_32x32x16_bf16 v[200:215], a[116:119], v[152:155], v[200:215]
    s_add_u32 s36, s14, 9216
    buffer_load_dwordx4 v[136:139], v2, s[64:67], s36 offen offset:0 sc1
    v_mfma_f32_32x32x16_bf16 v[216:231], a[112:115], v[156:159], v[216:231]
    v_mfma_f32_32x32x16_bf16 v[232:247], a[116:119], v[156:159], v[232:247]
    s_add_u32 s37, s14, 123904
    buffer_load_dwordx4 v[140:143], v2, s[64:67], s37 offen offset:0 sc1
    s_waitcnt vmcnt(12)
    v_mfma_f32_32x32x16_bf16 v[184:199], a[120:123], v[160:163], v[184:199]
    v_mfma_f32_32x32x16_bf16 v[200:215], a[124:127], v[160:163], v[200:215]
    buffer_load_dwordx4 v[144:147], v2, s[64:67], s36 offen offset:1024 sc1
    s_waitcnt vmcnt(12)
    v_mfma_f32_32x32x16_bf16 v[216:231], a[120:123], v[164:167], v[216:231]
    v_mfma_f32_32x32x16_bf16 v[232:247], a[124:127], v[164:167], v[232:247]
    buffer_load_dwordx4 v[148:151], v2, s[64:67], s37 offen offset:1024 sc1
    s_waitcnt vmcnt(12)
    v_mfma_f32_32x32x16_bf16 v[184:199], a[168:171], v[168:171], v[184:199]
    v_mfma_f32_32x32x16_bf16 v[200:215], a[172:175], v[168:171], v[200:215]
    s_add_u32 s36, s14, 16384
    buffer_load_dwordx4 v[152:155], v2, s[64:67], s36 offen offset:0 sc1
    s_waitcnt vmcnt(12)
    v_mfma_f32_32x32x16_bf16 v[216:231], a[168:171], v[172:175], v[216:231]
    v_mfma_f32_32x32x16_bf16 v[232:247], a[172:175], v[172:175], v[232:247]
    s_add_u32 s37, s14, 131072
    buffer_load_dwordx4 v[156:159], v2, s[64:67], s37 offen offset:0 sc1
    s_waitcnt vmcnt(12)
    v_mfma_f32_32x32x16_bf16 v[184:199], a[176:179], v[176:179], v[184:199]
    v_mfma_f32_32x32x16_bf16 v[200:215], a[180:183], v[176:179], v[200:215]
    s_buffer_load_dwordx8 s[44:51], s[64:67], s13 offset:256 glc
    buffer_load_dwordx4 v[160:163], v2, s[64:67], s36 offen offset:1024 sc1
    s_waitcnt vmcnt(12)
    v_mfma_f32_32x32x16_bf16 v[216:231], a[176:179], v[180:183], v[216:231]
    v_mfma_f32_32x32x16_bf16 v[232:247], a[180:183], v[180:183], v[232:247]
    buffer_load_dwordx4 v[164:167], v2, s[64:67], s37 offen offset:1024 sc1
    s_waitcnt vmcnt(12)
    v_mfma_f32_32x32x16_bf16 v[184:199], a[16:19], v[120:123], v[184:199]
    buffer_load_dwordx4 v13, s[64:67], s81 offen sc1 lds
    v_mfma_f32_32x32x16_bf16 v[200:215], a[20:23], v[120:123], v[200:215]
    s_add_u32 s36, s14, 23552
    buffer_load_dwordx4 v[168:171], v2, s[64:67], s36 offen offset:0 sc1
    s_waitcnt vmcnt(13)
    v_mfma_f32_32x32x16_bf16 v[216:231], a[16:19], v[124:127], v[216:231]
    buffer_load_dwordx4 v12, s[64:67], s84 offen offset:1024 sc1 lds
    v_mfma_f32_32x32x16_bf16 v[232:247], a[20:23], v[124:127], v[232:247]
    s_add_u32 s37, s14, 138240
    buffer_load_dwordx4 v[172:175], v2, s[64:67], s37 offen offset:0 sc1
    s_waitcnt vmcnt(14)
    v_mfma_f32_32x32x16_bf16 v[184:199], a[24:27], v[128:131], v[184:199]
    buffer_load_dwordx4 v[44:47], v78, s[64:67], s80 offen offset:0 sc1
    buffer_load_dwordx4 v[48:51], v78, s[64:67], s80 offen offset:16 sc1
    v_mfma_f32_32x32x16_bf16 v[200:215], a[28:31], v[128:131], v[200:215]
    buffer_load_dwordx4 v[176:179], v2, s[64:67], s36 offen offset:1024 sc1
    s_waitcnt vmcnt(15)
    v_mfma_f32_32x32x16_bf16 v[216:231], a[24:27], v[132:135], v[216:231]
    v_mfma_f32_32x32x16_bf16 v[232:247], a[28:31], v[132:135], v[232:247]
    buffer_load_dwordx4 v[180:183], v2, s[64:67], s37 offen offset:1024 sc1
    s_waitcnt vmcnt(15)
    v_mfma_f32_32x32x16_bf16 v[184:199], a[72:75], v[136:139], v[184:199]
    v_mfma_f32_32x32x16_bf16 v[200:215], a[76:79], v[136:139], v[200:215]
L_p2_chk:
    s_waitcnt lgkmcnt(0)
    s_xor_b64 s[44:45], s[44:45], s[52:53]
    s_xor_b64 s[46:47], s[46:47], s[52:53]
    s_xor_b64 s[48:49], s[48:49], s[52:53]
    s_xor_b64 s[50:51], s[50:51], s[52:53]
    s_or_b64 s[44:45], s[44:45], s[46:47]
    s_or_b64 s[48:49], s[48:49], s[50:51]
    s_or_b64 s[44:45], s[44:45], s[48:49]
    s_cbranch_scc1 L_p2_retry
L_p2_ok:
    s_add_u32 s36, s14, 4096
    buffer_load_dwordx4 v[120:123], v2, s[64:67], s36 offen offset:0 sc1
    s_waitcnt vmcnt(15)
    v_mfma_f32_32x32x16_bf16 v[216:231], a[72:75], v[140:143], v[216:231]
    v_mfma_f32_32x32x16_bf16 v[232:247], a[76:79], v[140:143], v[232:247]
    s_buffer_load_dwordx8 s[44:51], s[64:67], s13 offset:384 glc
    s_add_u32 s37, s14, 118784
    buffer_load_dwordx4 v[124:127], v2, s[64:67], s37 offen offset:0 sc1
    s_waitcnt vmcnt(15)
    v_mfma_f32_32x32x16_bf16 v[184:199], a[80:83], v[144:147], v[184:199]
    v_mfma_f32_32x32x16_bf16 v[200:215], a[84:87], v[144:147], v[200:215]
    s_add_u32 s36, s14, 11264
    buffer_load_dwordx4 v[128:131], v2, s[64:67], s36 offen offset:0 sc1
    s_waitcnt vmcnt(15)
    v_mfma_f32_32x32x16_bf16 v[216:231], a[80:83], v[148:151], v[216:231]
    v_mfma_f32_32x32x16_bf16 v[232:247], a[84:87], v[148:151], v[232:247]
    s_add_u32 s36, s14, 18432
    buffer_load_dwordx4 v[132:135], v2, s[64:67], s36 offen offset:0 sc1
    s_waitcnt vmcnt(15)
    v_mfma_f32_32x32x16_bf16 v[184:199], a[128:131], v[152:155], v[184:199]
    v_mfma_f32_32x32x16_bf16 v[200:215], a[132:135], v[152:155], v[200:215]
    s_add_u32 s36, s14, 25600
    buffer_load_dwordx4 v[136:139], v2, s[64:67], s36 offen offset:0 sc1
    s_waitcnt vmcnt(15)
    v_mfma_f32_32x32x16_bf16 v[216:231], a[128:131], v[156:159], v[216:231]
    v_mfma_f32_32x32x16_bf16 v[232:247], a[132:135], v[156:159], v[232:247]
L_p3_chk:
    s_waitcnt lgkmcnt(0)
    s_xor_b64 s[44:45], s[44:45], s[52:53]
    s_xor_b64 s[46:47], s[46:47], s[52:53]
    s_xor_b64 s[48:49], s[48:49], s[52:53]
    s_xor_b64 s[50:51], s[50:51], s[52:53]
    s_or_b64 s[44:45], s[44:45], s[46:47]
    s_or_b64 s[48:49], s[48:49], s[50:51]
    s_or_b64 s[44:45], s[44:45], s[48:49]
    s_cbranch_scc1 L_p3_retry
L_p3_ok:
    s_add_u32 s36, s14, 5120
    buffer_load_dwordx4 v[140:143], v2, s[64:67], s36 offen offset:0 sc1
    s_waitcnt vmcnt(15)
    v_mfma_f32_32x32x16_bf16 v[184:199], a[136:139], v[160:163], v[184:199]
    v_mfma_f32_32x32x16_bf16 v[200:215], a[140:143], v[160:163], v[200:215]
    buffer_load_dwordx4 v[144:147], v2, s[64:67], s36 offen offset:1024 sc1
    s_waitcnt vmcnt(15)
    v_mfma_f32_32x32x16_bf16 v[216:231], a[136:139], v[164:167], v[216:231]
    v_mfma_f32_32x32x16_bf16 v[232:247], a[140:143], v[164:167], v[232:247]
    s_add_u32 s36, s14, 12288
    buffer_load_dwordx4 v[148:151], v2, s[64:67], s36 offen offset:0 sc1
    s_waitcnt vmcnt(14)
    v_mfma_f32_32x32x16_bf16 v[184:199], a[184:187], v[168:171], v[184:199]
    v_mfma_f32_32x32x16_bf16 v[200:215], a[188:191], v[168:171], v[200:215]
    buffer_load_dwordx4 v[152:155], v2, s[64:67], s36 offen offset:1024 sc1
    s_waitcnt vmcnt(13)
    v_mfma_f32_32x32x16_bf16 v[216:231], a[184:187], v[172:175], v[216:231]
    v_mfma_f32_32x32x16_bf16 v[232:247], a[188:191], v[172:175], v[232:247]
    s_add_u32 s36, s14, 19456
    buffer_load_dwordx4 v[156:159], v2, s[64:67], s36 offen offset:0 sc1
    s_waitcnt vmcnt(11)
    v_mfma_f32_32x32x16_bf16 v[184:199], a[192:195], v[176:179], v[184:199]
    v_mfma_f32_32x32x16_bf16 v[200:215], a[196:199], v[176:179], v[200:215]
    buffer_load_dwordx4 v[160:163], v2, s[64:67], s36 offen offset:1024 sc1
    s_waitcnt vmcnt(11)
    v_mfma_f32_32x32x16_bf16 v[216:231], a[192:195], v[180:183], v[216:231]
    ds_read_b64_tr_b16 v[80:81], v253 offset:0
    ds_read_b64_tr_b16 v[82:83], v253 offset:256
    ds_read_b64_tr_b16 v[84:85], v253 offset:1024
    ds_read_b64_tr_b16 v[86:87], v253 offset:1280
    v_mfma_f32_32x32x16_bf16 v[232:247], a[196:199], v[180:183], v[232:247]
    s_add_u32 s36, s14, 26624
    buffer_load_dwordx4 v[164:167], v2, s[64:67], s36 offen offset:0 sc1
    s_waitcnt vmcnt(11)
    v_mfma_f32_32x32x16_bf16 v[184:199], a[32:35], v[120:123], v[184:199]
    v_mfma_f32_32x32x16_bf16 v[200:215], a[36:39], v[120:123], v[200:215]
    buffer_load_dwordx4 v[168:171], v2, s[64:67], s36 offen offset:1024 sc1
    s_waitcnt vmcnt(11)
    v_mfma_f32_32x32x16_bf16 v[216:231], a[32:35], v[124:127], v[216:231]
    v_mfma_f32_32x32x16_bf16 v[232:247], a[36:39], v[124:127], v[232:247]
    s_add_u32 s37, s14, 125952
    buffer_load_dwordx4 v[172:175], v2, s[64:67], s37 offen offset:0 sc1
    s_waitcnt vmcnt(11)
    v_mfma_f32_32x32x16_bf16 v[184:199], a[88:91], v[128:131], v[184:199]
    s_waitcnt lgkmcnt(2)
    ds_write_b128 v74, v[80:83] offset:0
    v_mfma_f32_32x32x16_bf16 v[200:215], a[92:95], v[128:131], v[200:215]
    s_add_u32 s37, s14, 133120
    buffer_load_dwordx4 v[176:179], v2, s[64:67], s37 offen offset:0 sc1
    s_waitcnt vmcnt(11)
    v_mfma_f32_32x32x16_bf16 v[184:199], a[144:147], v[132:135], v[184:199]
    s_waitcnt lgkmcnt(1)
    ds_write_b128 v74, v[84:87] offset:1024
    v_mfma_f32_32x32x16_bf16 v[200:215], a[148:151], v[132:135], v[200:215]
    s_add_u32 s37, s14, 140288
    buffer_load_dwordx4 v[180:183], v2, s[64:67], s37 offen offset:0 sc1
    s_waitcnt vmcnt(11)
    v_mfma_f32_32x32x16_bf16 v[184:199], a[200:203], v[136:139], v[184:199]
    v_mfma_f32_32x32x16_bf16 v[200:215], a[204:207], v[136:139], v[200:215]
    s_add_u32 s37, s14, 119808
    buffer_load_dwordx4 v[120:123], v2, s[64:67], s37 offen offset:0 sc1
    s_waitcnt vmcnt(11)
    v_mfma_f32_32x32x16_bf16 v[184:199], a[40:43], v[140:143], v[184:199]
    v_mfma_f32_32x32x16_bf16 v[200:215], a[44:47], v[140:143], v[200:215]
    buffer_load_dwordx4 v[124:127], v2, s[64:67], s37 offen offset:1024 sc1
    s_waitcnt vmcnt(11)
    v_mfma_f32_32x32x16_bf16 v[184:199], a[48:51], v[144:147], v[184:199]
    v_mfma_f32_32x32x16_bf16 v[200:215], a[52:55], v[144:147], v[200:215]
    s_add_u32 s37, s14, 126976
    buffer_load_dwordx4 v[128:131], v2, s[64:67], s37 offen offset:0 sc1
    s_waitcnt vmcnt(11)
    v_mfma_f32_32x32x16_bf16 v[184:199], a[96:99], v[148:151], v[184:199]
    v_mfma_f32_32x32x16_bf16 v[200:215], a[100:103], v[148:151], v[200:215]
    buffer_load_dwordx4 v[132:135], v2, s[64:67], s37 offen offset:1024 sc1
    s_waitcnt vmcnt(11)
    v_mfma_f32_32x32x16_bf16 v[184:199], a[104:107], v[152:155], v[184:199]
    v_mfma_f32_32x32x16_bf16 v[200:215], a[108:111], v[152:155], v[200:215]
    s_add_u32 s37, s14, 134144
    buffer_load_dwordx4 v[136:139], v2, s[64:67], s37 offen offset:0 sc1
    s_waitcnt vmcnt(11)
    v_mfma_f32_32x32x16_bf16 v[184:199], a[152:155], v[156:159], v[184:199]
    v_mfma_f32_32x32x16_bf16 v[200:215], a[156:159], v[156:159], v[200:215]
    buffer_load_dwordx4 v[140:143], v2, s[64:67], s37 offen offset:1024 sc1
    s_waitcnt vmcnt(11)
    v_mfma_f32_32x32x16_bf16 v[184:199], a[160:163], v[160:163], v[184:199]
    v_mfma_f32_32x32x16_bf16 v[200:215], a[164:167], v[160:163], v[200:215]
    s_add_u32 s37, s14, 141312
    buffer_load_dwordx4 v[144:147], v2, s[64:67], s37 offen offset:0 sc1
    s_waitcnt vmcnt(11)
    v_mfma_f32_32x32x16_bf16 v[184:199], a[208:211], v[164:167], v[184:199]
    v_mfma_f32_32x32x16_bf16 v[200:215], a[212:215], v[164:167], v[200:215]
    buffer_load_dwordx4 v[148:151], v2, s[64:67], s37 offen offset:1024 sc1
    s_waitcnt vmcnt(11)
    v_mfma_f32_32x32x16_bf16 v[184:199], a[216:219], v[168:171], v[184:199]
    v_mfma_f32_32x32x16_bf16 v[200:215], a[220:223], v[168:171], v[200:215]
    s_waitcnt vmcnt(10)
    v_mfma_f32_32x32x16_bf16 v[216:231], a[88:91], v[172:175], v[216:231]
    v_mfma_f32_32x32x16_bf16 v[232:247], a[92:95], v[172:175], v[232:247]
    s_waitcnt vmcnt(9)
    v_mfma_f32_32x32x16_bf16 v[216:231], a[144:147], v[176:179], v[216:231]
    s_nop 5
    ds_write_b128 v76, v[184:187] offset:0
    v_mfma_f32_32x32x16_bf16 v[232:247], a[148:151], v[176:179], v[232:247]
    ds_write_b128 v76, v[188:191] offset:1024
    s_waitcnt vmcnt(8)
    v_mfma_f32_32x32x16_bf16 v[216:231], a[200:203], v[180:183], v[216:231]
    ds_write_b128 v77, v[192:195] offset:4096
    v_mfma_f32_32x32x16_bf16 v[232:247], a[204:207], v[180:183], v[232:247]
    ds_write_b128 v77, v[196:199] offset:5120
    s_waitcnt vmcnt(7)
    v_mfma_f32_32x32x16_bf16 v[216:231], a[40:43], v[120:123], v[216:231]
    ds_write_b128 v76, v[200:203] offset:2048
    v_mfma_f32_32x32x16_bf16 v[232:247], a[44:47], v[120:123], v[232:247]
    ds_write_b128 v76, v[204:207] offset:3072
    s_waitcnt vmcnt(6)
    v_mfma_f32_32x32x16_bf16 v[216:231], a[48:51], v[124:127], v[216:231]
    ds_write_b128 v77, v[208:211] offset:6144
    v_mfma_f32_32x32x16_bf16 v[232:247], a[52:55], v[124:127], v[232:247]
    ds_write_b128 v77, v[212:215] offset:7168
    s_waitcnt vmcnt(5)
    v_mfma_f32_32x32x16_bf16 v[216:231], a[96:99], v[128:131], v[216:231]
    s_waitcnt vmcnt(4)
    v_mfma_f32_32x32x16_bf16 v[216:231], a[104:107], v[132:135], v[216:231]
    s_waitcnt lgkmcnt(0)
    s_barrier
    ds_read_b128 v[80:83], v73 offset:0
    ds_read_b128 v[84:87], v73 offset:1024
    s_waitcnt vmcnt(3)
    v_mfma_f32_32x32x16_bf16 v[216:231], a[152:155], v[136:139], v[216:231]
    ds_read_b128 v[88:91], v72 offset:0
    ds_read_b128 v[92:95], v72 offset:1024
    ds_read_b128 v[96:99], v72 offset:16384
    ds_read_b128 v[100:103], v72 offset:17408
    ds_read_b128 v[104:107], v72 offset:32768
    ds_read_b128 v[108:111], v72 offset:33792
    s_waitcnt vmcnt(2)
    v_mfma_f32_32x32x16_bf16 v[216:231], a[160:163], v[140:143], v[216:231]
    ds_read_b128 v[112:115], v72 offset:49152
    ds_read_b128 v[116:119], v72 offset:50176
    s_waitcnt vmcnt(1)
    v_mfma_f32_32x32x16_bf16 v[216:231], a[208:211], v[144:147], v[216:231]
    s_waitcnt vmcnt(0)
    v_mfma_f32_32x32x16_bf16 v[216:231], a[216:219], v[148:151], v[216:231]
    s_waitcnt lgkmcnt(0)
    v_lshlrev_b32_e64 v56, 16, v80
    v_and_b32 v57, 0xffff0000, v80
    v_lshlrev_b32_e64 v58, 16, v81
    v_and_b32 v59, 0xffff0000, v81
    v_mfma_f32_32x32x16_bf16 v[232:247], a[100:103], v[128:131], v[232:247]
    v_lshlrev_b32_e64 v60, 16, v82
    v_and_b32 v61, 0xffff0000, v82
    v_lshlrev_b32_e64 v62, 16, v83
    v_and_b32 v63, 0xffff0000, v83
    v_add_f32 v88, v88, v96
    v_add_f32 v89, v89, v97
    v_mfma_f32_32x32x16_bf16 v[232:247], a[108:111], v[132:135], v[232:247]
    v_add_f32 v90, v90, v98
    v_add_f32 v91, v91, v99
    v_add_f32 v92, v92, v100
    v_add_f32 v93, v93, v101
    v_add_f32_e64 v94, v94, v102
    v_mfma_f32_32x32x16_bf16 v[232:247], a[156:159], v[136:139], v[232:247]
    v_add_f32 v95, v95, v103
    v_add_f32 v104, v104, v112
    ds_write_b128 v76, v[216:219] offset:8192
    v_mfma_f32_32x32x16_bf16 v[232:247], a[164:167], v[140:143], v[232:247]
    v_add_f32 v105, v105, v113
    v_add_f32 v106, v106, v114
    ds_write_b128 v76, v[220:223] offset:9216
    v_mfma_f32_32x32x16_bf16 v[232:247], a[212:215], v[144:147], v[232:247]
    v_add_f32 v107, v107, v115
    v_add_f32 v108, v108, v116
    ds_write_b128 v77, v[224:227] offset:12288
    v_mfma_f32_32x32x16_bf16 v[232:247], a[220:223], v[148:151], v[232:247]
    v_add_f32 v109, v109, v117
    v_add_f32 v110, v110, v118
    ds_write_b128 v77, v[228:231] offset:13312
    v_add_f32 v111, v111, v119
    v_add_f32 v88, v88, v104
    v_add_f32 v89, v89, v105
    v_add_f32 v90, v90, v106
    v_add_f32 v91, v91, v107
    v_add_f32 v92, v92, v108
    v_add_f32_e64 v93, v93, v109
    v_add_f32 v94, v94, v110
    s_nop 0
    ds_write_b128 v76, v[232:235] offset:10240
    v_add_f32_e64 v95, v95, v111
    v_fma_f32 v88, v88, v44, v56
    v_fma_f32 v89, v89, v45, v57
    ds_write_b128 v76, v[236:239] offset:11264
    v_fma_f32 v90, v90, v46, v58
    v_fma_f32 v91, v91, v47, v59
    v_fma_f32 v92, v92, v48, v60
    ds_write_b128 v77, v[240:243] offset:14336
    v_fma_f32 v93, v93, v49, v61
    v_fma_f32 v94, v94, v50, v62
    v_fma_f32 v95, v95, v51, v63
    ds_write_b128 v77, v[244:247] offset:15360
    v_cvt_pk_bf16_f32 v8, v88, v89
    v_cvt_pk_bf16_f32 v9, v90, v91
    v_cvt_pk_bf16_f32 v10, v92, v93
    s_waitcnt lgkmcnt(0)
    s_barrier
    ds_read_b128 v[120:123], v72 offset:8192
    ds_read_b128 v[124:127], v72 offset:9216
    ds_read_b128 v[128:131], v72 offset:24576
    ds_read_b128 v[132:135], v72 offset:25600
    ds_read_b128 v[136:139], v72 offset:40960
    ds_read_b128 v[140:143], v72 offset:41984
    ds_read_b128 v[144:147], v72 offset:57344
    ds_read_b128 v[148:151], v72 offset:58368
    v_cvt_pk_bf16_f32 v11, v94, v95
    buffer_store_dwordx4 v[8:11], v75, s[60:63], s82 offen sc1
    v_lshlrev_b32_e64 v64, 16, v84
    v_and_b32 v65, 0xffff0000, v84
    v_lshlrev_b32_e64 v66, 16, v85
    v_and_b32 v67, 0xffff0000, v85
    v_lshlrev_b32_e64 v68, 16, v86
    v_and_b32 v69, 0xffff0000, v86
    v_lshlrev_b32_e64 v70, 16, v87
    v_and_b32 v71, 0xffff0000, v87
    s_waitcnt lgkmcnt(5)
    v_pk_add_f32 v[120:121], v[120:121], v[128:129]
    v_pk_add_f32 v[122:123], v[122:123], v[130:131]
    s_waitcnt lgkmcnt(4)
    v_pk_add_f32 v[124:125], v[124:125], v[132:133]
    v_pk_add_f32 v[126:127], v[126:127], v[134:135]
    s_waitcnt lgkmcnt(1)
    v_pk_add_f32 v[136:137], v[136:137], v[144:145]
    v_pk_add_f32 v[138:139], v[138:139], v[146:147]
    s_waitcnt lgkmcnt(0)
    v_pk_add_f32 v[140:141], v[140:141], v[148:149]
    v_pk_add_f32 v[142:143], v[142:143], v[150:151]
    v_pk_add_f32 v[120:121], v[120:121], v[136:137]
    v_pk_add_f32 v[122:123], v[122:123], v[138:139]
    v_pk_add_f32 v[124:125], v[124:125], v[140:141]
    v_pk_add_f32 v[126:127], v[126:127], v[142:143]
    v_pk_fma_f32 v[120:121], v[120:121], v[44:45], v[64:65]
    v_pk_fma_f32 v[122:123], v[122:123], v[46:47], v[66:67]
    v_pk_fma_f32 v[124:125], v[124:125], v[48:49], v[68:69]
    v_pk_fma_f32 v[126:127], v[126:127], v[50:51], v[70:71]
    v_cvt_pk_bf16_f32 v12, v120, v121
    v_cvt_pk_bf16_f32 v13, v122, v123
    v_cvt_pk_bf16_f32 v14, v124, v125
    v_cvt_pk_bf16_f32 v15, v126, v127
    buffer_store_dwordx4 v[12:15], v75, s[60:63], s83 offen sc1
L_adaLN_cond__ssm_conv_s4__geglu_ffn__prompt_kernel_exit:
    s_endpgm
L_ka_retry:
    s_add_u32 s98, s98, 1
    s_cmp_gt_u32 s98, 20000
    s_cbranch_scc1 L_ka_ok
    s_waitcnt vmcnt(0)
    s_mul_i32 s94, s74, 12288
    s_add_u32 s94, s94, 1048576
    buffer_load_dwordx4 v[160:163], v12, s[64:67], s94 offen sc1
    s_mov_b32 s79, 65536
    buffer_load_dwordx4 v[172:175], v12, s[64:67], s79 offen sc1
    s_add_u32 s94, s94, 4096
    buffer_load_dwordx4 v[164:167], v12, s[64:67], s94 offen sc1
    s_mov_b32 s79, 69632
    buffer_load_dwordx4 v[176:179], v12, s[64:67], s79 offen sc1
    s_add_u32 s94, s94, 4096
    buffer_load_dwordx4 v[168:171], v12, s[64:67], s94 offen sc1
    s_mov_b32 s79, 73728
    buffer_load_dwordx4 v[180:183], v12, s[64:67], s79 offen sc1
    s_lshl4_add_u32 s3, s74, 524288
    buffer_load_dwordx4 v[184:187], v13, s[64:67], s3 offen sc1
    s_waitcnt vmcnt(0) lgkmcnt(0)
    s_branch L_ka_chk
L_q_retry:
    s_add_u32 s98, s98, 1
    s_cmp_gt_u32 s98, 20000
    s_cbranch_scc1 L_q_ok
    s_waitcnt vmcnt(0)
    s_lshl4_add_u32 s3, s74, 655360
    buffer_load_dwordx4 v[144:147], v243, s[64:67], s3 offen sc1
    s_lshl2_add_u32 s3, s27, s75
    s_lshl_b32 s3, s3, 7
    s_add_u32 s3, s3, 688128
    buffer_load_dwordx4 v[148:151], v14, s[64:67], s3 offen sc1
    s_add_u32 s3, s3, 16384
    buffer_load_dwordx4 v[152:155], v14, s[64:67], s3 offen sc1
    s_waitcnt vmcnt(0) lgkmcnt(0)
    s_branch L_q_chk
L_fd_retry:
    s_add_u32 s21, s21, 1
    s_cmp_gt_u32 s21, 40000
    s_cbranch_scc1 L_fd_ok
    s_waitcnt vmcnt(0)
    buffer_load_dword v247, v246, s[64:67], s93 offen offset:0 sc1
    s_waitcnt vmcnt(0) lgkmcnt(0)
    s_branch L_fd_chk
L_fx_retry:
    s_add_u32 s21, s21, 1
    s_cmp_gt_u32 s21, 40000
    s_cbranch_scc1 L_fx_ok
    s_waitcnt vmcnt(0)
    buffer_load_dword v247, v246, s[64:67], s99 offen offset:0 sc1
    s_waitcnt vmcnt(0) lgkmcnt(0)
    s_branch L_fx_chk
L_p0_retry:
    s_add_u32 s21, s21, 1
    s_cmp_gt_u32 s21, 40000
    s_cbranch_scc1 L_p0_ok
    s_waitcnt vmcnt(0)
    buffer_load_dword v252, v254, s[64:67], s13 offen offset:0 sc1
    s_waitcnt vmcnt(0) lgkmcnt(0)
    s_branch L_p0_chk
L_p1_retry:
    s_add_u32 s21, s21, 1
    s_cmp_gt_u32 s21, 40000
    s_cbranch_scc1 L_p1_ok
    s_buffer_load_dwordx8 s[44:51], s[64:67], s13 offset:128 glc
    s_branch L_p1_chk
L_p2_retry:
    s_add_u32 s21, s21, 1
    s_cmp_gt_u32 s21, 40000
    s_cbranch_scc1 L_p2_ok
    s_buffer_load_dwordx8 s[44:51], s[64:67], s13 offset:256 glc
    s_branch L_p2_chk
L_p3_retry:
    s_add_u32 s21, s21, 1
    s_cmp_gt_u32 s21, 40000
    s_cbranch_scc1 L_p3_ok
    s_buffer_load_dwordx8 s[44:51], s[64:67], s13 offset:384 glc
    s_branch L_p3_chk
.p2align 8
.type L_table,@object
L_table:
.long 0xc800c80,0xc800c80,0xc6c0c6c,0xc6c0c6c,0xc6c0c6c,0xc680c6c,0xc680c68,0xc680c68
.long 0xc680c68,0xc680c68,0xc640c64,0xc640c64,0xc640c64,0xc600c64,0xc600c60,0xc600c60
.long 0xc600c60,0xc600c60,0xc5c0c5c,0xc5c0c5c,0xc5c0c5c,0xc580c5c,0xc580c58,0xc580c58
.long 0xc580c58,0xc580c58,0xc540c54,0xc540c54,0xc540c54,0xc500c54,0xc500c50,0xc500c50
.long 0xc500c50,0xc500c50,0xc4c0c4c,0xc4c0c4c,0xc4c0c4c,0xc480c4c,0xc480c48,0xc480c48
.long 0xc480c48,0xc480c48,0xc440c44,0xc440c44,0xc440c44,0xc400c44,0xc400c40,0xc400c40
.long 0xc400c40,0xc400c40,0xc3c0c3c,0xc3c0c3c,0xc3c0c3c,0xc380c3c,0xc380c38,0xc380c38
.long 0xc380c38,0xc380c38,0xc340c34,0xc340c34,0xc340c34,0xc300c34,0xc300c30,0xc300c30
.long 0xc300c30,0xc300c30,0xc1c0c1c,0xc1c0c1c,0xc1c0c1c,0xc180c1c,0xc180c18,0xc180c18
.long 0xc180c18,0xc180c18,0xc140c14,0xc140c14,0xc140c14,0xc100c14,0xc100c10,0xc100c10
.long 0xc100c10,0xc100c10,0xc0c0c0c,0xc0c0c0c,0xc0c0c0c,0xc080c0c,0xc080c08,0xc080c08
.long 0xc080c08,0xc080c08,0xc040c04,0xc040c04,0xc040c04,0xc000c04,0xc000c00,0xc000c00
.long 0xc000c00,0xc000c00,0xbfc0bfc,0xbfc0bfc,0xbfc0bfc,0xbf80bfc,0xbf80bf8,0xbf80bf8
.long 0xbf80bf8,0xbf80bf8,0xbf40bf4,0xbf40bf4,0xbf40bf4,0xbf00bf4,0xbf00bf0,0xbf00bf0
.long 0xbf00bf0,0xbf00bf0,0xbec0bec,0xbec0bec,0xbec0bec,0xbe80bec,0xbe80be8,0xbe80be8
.long 0xbe80be8,0xbe80be8,0xbe40be4,0xbe40be4,0xbe40be4,0xbe00be4,0xbe00be0,0xbe00be0
.long 0xbe00be0,0xbe00be0,0xbcc0bcc,0xbcc0bcc,0xbcc0bcc,0xbc80bcc,0xbc80bc8,0xbc80bc8
.long 0xbc80bc8,0xbc80bc8,0xbc40bc4,0xbc40bc4,0xbc40bc4,0xbc00bc4,0xbc00bc0,0xbc00bc0
.long 0xbc00bc0,0xbc00bc0,0xbbc0bbc,0xbbc0bbc,0xbbc0bbc,0xbb80bbc,0xbb80bb8,0xbb80bb8
.long 0xbb80bb8,0xbb80bb8,0xbb40bb4,0xbb40bb4,0xbb40bb4,0xbb00bb4,0xbb00bb0,0xbb00bb0
.long 0xbb00bb0,0xbb00bb0,0xbac0bac,0xbac0bac,0xbac0bac,0xba80bac,0xba80ba8,0xba80ba8
.long 0xba80ba8,0xba80ba8,0xba40ba4,0xba40ba4,0xba40ba4,0xba00ba4,0xba00ba0,0xba00ba0
.long 0xba00ba0,0xba00ba0,0xb9c0b9c,0xb9c0b9c,0xb9c0b9c,0xb980b9c,0xb980b98,0xb980b98
.long 0xb980b98,0xb980b98,0xb940b94,0xb940b94,0xb940b94,0xb900b94,0xb900b90,0xb900b90
.long 0xb900b90,0xb900b90,0xb7c0b7c,0xb7c0b7c,0xb7c0b7c,0xb780b7c,0xb780b78,0xb780b78
.long 0xb780b78,0xb780b78,0xb740b74,0xb740b74,0xb740b74,0xb700b74,0xb700b70,0xb700b70
.long 0xb700b70,0xb700b70,0xb6c0b6c,0xb6c0b6c,0xb6c0b6c,0xb680b6c,0xb680b68,0xb680b68
.long 0xb680b68,0xb680b68,0xb640b64,0xb640b64,0xb640b64,0xb600b64,0xb600b60,0xb600b60
.long 0xb600b60,0xb600b60,0xb5c0b5c,0xb5c0b5c,0xb5c0b5c,0xb580b5c,0xb580b58,0xb580b58
.long 0xb580b58,0xb580b58,0xb540b54,0xb540b54,0xb540b54,0xb500b54,0xb500b50,0xb500b50
.long 0xb500b50,0xb500b50,0xb4c0b4c,0xb4c0b4c,0xb4c0b4c,0xb480b4c,0xb480b48,0xb480b48
.long 0xb480b48,0xb480b48,0xb440b44,0xb440b44,0xb440b44,0xb400b44,0xb400b40,0xb400b40
.long 0xb400b40,0xb400b40,0xb2c0b2c,0xb2c0b2c,0xb2c0b2c,0xb280b2c,0xb280b28,0xb280b28
.long 0xb280b28,0xb280b28,0xb240b24,0xb240b24,0xb240b24,0xb200b24,0xb200b20,0xb200b20
.long 0xb200b20,0xb200b20,0xb1c0b1c,0xb1c0b1c,0xb1c0b1c,0xb180b1c,0xb180b18,0xb180b18
.long 0xb180b18,0xb180b18,0xb140b14,0xb140b14,0xb140b14,0xb100b14,0xb100b10,0xb100b10
.long 0xb100b10,0xb100b10,0xb0c0b0c,0xb0c0b0c,0xb0c0b0c,0xb080b0c,0xb080b08,0xb080b08
.long 0xb080b08,0xb080b08,0xb040b04,0xb040b04,0xb040b04,0xb000b04,0xb000b00,0xb000b00
.long 0xb000b00,0xb000b00,0xafc0afc,0xafc0afc,0xafc0afc,0xaf80afc,0xaf80af8,0xaf80af8
.long 0xaf80af8,0xaf80af8,0xaf40af4,0xaf40af4,0xaf40af4,0xaf00af4,0xaf00af0,0xaf00af0
.long 0xaf00af0,0xaf00af0,0xadc0adc,0xadc0adc,0xadc0adc,0xad80adc,0xad80ad8,0xad80ad8
.long 0xad80ad8,0xad80ad8,0xad40ad4,0xad40ad4,0xad40ad4,0xad00ad4,0xad00ad0,0xad00ad0
.long 0xad00ad0,0xad00ad0,0xacc0acc,0xacc0acc,0xacc0acc,0xac80acc,0xac80ac8,0xac80ac8
.long 0xac80ac8,0xac80ac8,0xac40ac4,0xac40ac4,0xac40ac4,0xac00ac4,0xac00ac0,0xac00ac0
.long 0xac00ac0,0xac00ac0,0xabc0abc,0xabc0abc,0xabc0abc,0xab80abc,0xab80ab8,0xab80ab8
.long 0xab80ab8,0xab80ab8,0xab40ab4,0xab40ab4,0xab40ab4,0xab00ab4,0xab00ab0,0xab00ab0
.long 0xab00ab0,0xab00ab0,0xaac0aac,0xaac0aac,0xaac0aac,0xaa80aac,0xaa80aa8,0xaa80aa8
.long 0xaa80aa8,0xaa80aa8,0xaa40aa4,0xaa40aa4,0xaa40aa4,0xaa00aa4,0xaa00aa0,0xaa00aa0
.long 0xaa00aa0,0xaa00aa0,0xa8c0a8c,0xa8c0a8c,0xa8c0a8c,0xa880a8c,0xa880a88,0xa880a88
.long 0xa880a88,0xa880a88,0xa840a84,0xa840a84,0xa840a84,0xa800a84,0xa800a80,0xa800a80
.long 0xa800a80,0xa800a80,0xa7c0a7c,0xa7c0a7c,0xa7c0a7c,0xa780a7c,0xa780a78,0xa780a78
.long 0xa780a78,0xa780a78,0xa740a74,0xa740a74,0xa740a74,0xa700a74,0xa700a70,0xa700a70
.long 0xa700a70,0xa700a70,0xa6c0a6c,0xa6c0a6c,0xa6c0a6c,0xa680a6c,0xa680a68,0xa680a68
.long 0xa680a68,0xa680a68,0xa640a64,0xa640a64,0xa640a64,0xa600a64,0xa600a60,0xa600a60
.long 0xa600a60,0xa600a60,0xa5c0a5c,0xa5c0a5c,0xa5c0a5c,0xa580a5c,0xa580a58,0xa580a58
.long 0xa580a58,0xa580a58,0xa540a54,0xa540a54,0xa540a54,0xa500a54,0xa500a50,0xa500a50
.long 0xa500a50,0xa500a50,0xa3c0a3c,0xa3c0a3c,0xa3c0a3c,0xa380a3c,0xa380a38,0xa380a38
.long 0xa380a38,0xa380a38,0xa340a34,0xa340a34,0xa340a34,0xa300a34,0xa300a30,0xa300a30
.long 0xa300a30,0xa300a30,0xa2c0a2c,0xa2c0a2c,0xa2c0a2c,0xa280a2c,0xa280a28,0xa280a28
.long 0xa280a28,0xa280a28,0xa240a24,0xa240a24,0xa240a24,0xa200a24,0xa200a20,0xa200a20
.long 0xa200a20,0xa200a20,0xa1c0a1c,0xa1c0a1c,0xa1c0a1c,0xa180a1c,0xa180a18,0xa180a18
.long 0xa180a18,0xa180a18,0xa140a14,0xa140a14,0xa140a14,0xa100a14,0xa100a10,0xa100a10
.long 0xa100a10,0xa100a10,0xa0c0a0c,0xa0c0a0c,0xa0c0a0c,0xa080a0c,0xa080a08,0xa080a08
.long 0xa080a08,0xa080a08,0xa040a04,0xa040a04,0xa040a04,0xa000a04,0xa000a00,0xa000a00
.long 0xa000a00,0x9ec09ec,0x99c09ec,0x99c099c,0x99c099c,0x9e809e8,0x99809e8,0x9980998
.long 0x9980998,0x9e409e4,0x99409e4,0x9940994,0x9940994,0x9e009e0,0x99009e0,0x9900990
.long 0x9900990,0x9dc09dc,0x98c09dc,0x98c098c,0x98c098c,0x9d809d8,0x98809d8,0x9880988
.long 0x9880988,0x9d409d4,0x98409d4,0x9840984,0x9840984,0x9d009d0,0x98009d0,0x9800980
.long 0x9800980,0x9cc09cc,0x97c09cc,0x97c097c,0x97c097c,0x9c809c8,0x97809c8,0x9780978
.long 0x9780978,0x9c409c4,0x97409c4,0x9740974,0x9740974,0x9c009c0,0x97009c0,0x9700970
.long 0x9700970,0x9bc09bc,0x96c09bc,0x96c096c,0x96c096c,0x9b809b8,0x96809b8,0x9680968
.long 0x9680968,0x9b409b4,0x96409b4,0x9640964,0x9640964,0x9b009b0,0x96009b0,0x9600960
.long 0x9600960,0x94c094c,0x8fc094c,0x8fc08fc,0x8fc08fc,0x9480948,0x8f80948,0x8f808f8
.long 0x8f808f8,0x9440944,0x8f40944,0x8f408f4,0x8f408f4,0x9400940,0x8f00940,0x8f008f0
.long 0x8f008f0,0x93c093c,0x8ec093c,0x8ec08ec,0x8ec08ec,0x9380938,0x8e80938,0x8e808e8
.long 0x8e808e8,0x9340934,0x8e40934,0x8e408e4,0x8e408e4,0x9300930,0x8e00930,0x8e008e0
.long 0x8e008e0,0x92c092c,0x8dc092c,0x8dc08dc,0x8dc08dc,0x9280928,0x8d80928,0x8d808d8
.long 0x8d808d8,0x9240924,0x8d40924,0x8d408d4,0x8d408d4,0x9200920,0x8d00920,0x8d008d0
.long 0x8d008d0,0x91c091c,0x8cc091c,0x8cc08cc,0x8cc08cc,0x9180918,0x8c80918,0x8c808c8
.long 0x8c808c8,0x9140914,0x8c40914,0x8c408c4,0x8c408c4,0x9100910,0x8c00910,0x8c008c0
.long 0x8c008c0,0x8ac08ac,0x85c08ac,0x85c085c,0x85c085c,0x8a808a8,0x85808a8,0x8580858
.long 0x8580858,0x8a408a4,0x85408a4,0x8540854,0x8540854,0x8a008a0,0x85008a0,0x8500850
.long 0x8500850,0x89c089c,0x84c089c,0x84c084c,0x84c084c,0x8980898,0x8480898,0x8480848
.long 0x8480848,0x8940894,0x8440894,0x8440844,0x8440844,0x8900890,0x8400890,0x8400840
.long 0x8400840,0x88c088c,0x83c088c,0x83c083c,0x83c083c,0x8880888,0x8380888,0x8380838
.long 0x8380838,0x8840884,0x8340884,0x8340834,0x8340834,0x8800880,0x8300880,0x8300830
.long 0x8300830,0x87c087c,0x82c087c,0x82c082c,0x82c082c,0x8780878,0x8280878,0x8280828
.long 0x8280828,0x8740874,0x8240874,0x8240824,0x8240824,0x8700870,0x8200870,0x8200820
.long 0x8200820,0x80c080c,0x7bc080c,0x7bc07bc,0x7bc07bc,0x8080808,0x7b80808,0x7b807b8
.long 0x7b807b8,0x8040804,0x7b40804,0x7b407b4,0x7b407b4,0x8000800,0x7b00800,0x7b007b0
.long 0x7b007b0,0x7fc07fc,0x7ac07fc,0x7ac07ac,0x7ac07ac,0x7f807f8,0x7a807f8,0x7a807a8
.long 0x7a807a8,0x7f407f4,0x7a407f4,0x7a407a4,0x7a407a4,0x7f007f0,0x7a007f0,0x7a007a0
.long 0x7a007a0,0x7ec07ec,0x79c07ec,0x79c079c,0x79c079c,0x7e807e8,0x79807e8,0x7980798
.long 0x7980798,0x7e407e4,0x79407e4,0x7940794,0x7940794,0x7e007e0,0x79007e0,0x7900790
.long 0x7900790,0x7dc07dc,0x78c07dc,0x78c078c,0x78c078c,0x7d807d8,0x78807d8,0x7880788
.long 0x7880788,0x7d407d4,0x78407d4,0x7840784,0x7840784,0x7d007d0,0x78007d0,0x7800780
.long 0x76c0780,0x71c071c,0x6cc071c,0x67c067c,0x768067c,0x7180718,0x6c80718,0x6780678
.long 0x7640678,0x7140714,0x6c40714,0x6740674,0x7600674,0x7100710,0x6c00710,0x6700670
.long 0x75c0670,0x70c070c,0x6bc070c,0x66c066c,0x758066c,0x7080708,0x6b80708,0x6680668
.long 0x7540668,0x7040704,0x6b40704,0x6640664,0x7500664,0x7000700,0x6b00700,0x6600660
.long 0x74c0660,0x6fc06fc,0x6ac06fc,0x65c065c,0x748065c,0x6f806f8,0x6a806f8,0x6580658
.long 0x7440658,0x6f406f4,0x6a406f4,0x6540654,0x7400654,0x6f006f0,0x6a006f0,0x6500650
.long 0x73c0650,0x6ec06ec,0x69c06ec,0x64c064c,0x738064c,0x6e806e8,0x69806e8,0x6480648
.long 0x7340648,0x6e406e4,0x69406e4,0x6440644,0x7300644,0x6e006e0,0x69006e0,0x6400640
.long 0x62c0640,0x5dc05dc,0x58c05dc,0x53c053c,0x628053c,0x5d805d8,0x58805d8,0x5380538
.long 0x6240538,0x5d405d4,0x58405d4,0x5340534,0x6200534,0x5d005d0,0x58005d0,0x5300530
.long 0x61c0530,0x5cc05cc,0x57c05cc,0x52c052c,0x618052c,0x5c805c8,0x57805c8,0x5280528
.long 0x6140528,0x5c405c4,0x57405c4,0x5240524,0x6100524,0x5c005c0,0x57005c0,0x5200520
.long 0x60c0520,0x5bc05bc,0x56c05bc,0x51c051c,0x608051c,0x5b805b8,0x56805b8,0x5180518
.long 0x6040518,0x5b405b4,0x56405b4,0x5140514,0x6000514,0x5b005b0,0x56005b0,0x5100510
.long 0x5fc0510,0x5ac05ac,0x55c05ac,0x50c050c,0x5f8050c,0x5a805a8,0x55805a8,0x5080508
.long 0x5f40508,0x5a405a4,0x55405a4,0x5040504,0x5f00504,0x5a005a0,0x55005a0,0x5000500
.long 0x49c04ec,0x3fc044c,0x35c03ac,0x2bc030c,0x49804e8,0x3f80448,0x35803a8,0x2b80308
.long 0x49404e4,0x3f40444,0x35403a4,0x2b40304,0x49004e0,0x3f00440,0x35003a0,0x2b00300
.long 0x48c04dc,0x3ec043c,0x34c039c,0x2ac02fc,0x48804d8,0x3e80438,0x3480398,0x2a802f8
.long 0x48404d4,0x3e40434,0x3440394,0x2a402f4,0x48004d0,0x3e00430,0x3400390,0x2a002f0
.long 0x47c04cc,0x3dc042c,0x33c038c,0x29c02ec,0x47804c8,0x3d80428,0x3380388,0x29802e8
.long 0x47404c4,0x3d40424,0x3340384,0x29402e4,0x47004c0,0x3d00420,0x3300380,0x29002e0
.long 0x46c04bc,0x3cc041c,0x32c037c,0x28c02dc,0x46804b8,0x3c80418,0x3280378,0x28802d8
.long 0x46404b4,0x3c40414,0x3240374,0x28402d4,0x46004b0,0x3c00410,0x3200370,0x28002d0
.long 0x21c026c,0x17c01cc,0xdc012c,0x3c008c,0x2180268,0x17801c8,0xd80128,0x380088
.long 0x2140264,0x17401c4,0xd40124,0x340084,0x2100260,0x17001c0,0xd00120,0x300080
.long 0x20c025c,0x16c01bc,0xcc011c,0x2c007c,0x2080258,0x16801b8,0xc80118,0x280078
.long 0x2040254,0x16401b4,0xc40114,0x240074,0x2000250,0x16001b0,0xc00110,0x200070
.long 0x1fc024c,0x15c01ac,0xbc010c,0x1c006c,0x1f80248,0x15801a8,0xb80108,0x180068
.long 0x1f40244,0x15401a4,0xb40104,0x140064,0x1f00240,0x15001a0,0xb00100,0x100060
.long 0x1ec023c,0x14c019c,0xac00fc,0xc005c,0x1e80238,0x1480198,0xa800f8,0x80058
.long 0x1e40234,0x1440194,0xa400f4,0x40054,0x1e00230,0x1400190,0xa000f0,0x50
.long 0xc6c0c6c,0xc6c,0x12118,0x1a300,0xc680c68,0xc68,0x13158,0x1a320
.long 0xc640c64,0xc64,0x14198,0x1a340,0xc600c60,0xc60,0x151d8,0x1a360
.long 0xc5c0c5c,0xc5c,0x12110,0x1a380,0xc580c58,0xc58,0x13150,0x1a3a0
.long 0xc540c54,0xc54,0x14190,0x1a3c0,0xc500c50,0xc50,0x151d0,0x1a3e0
.long 0xc4c0c4c,0xc4c,0x12108,0x1a400,0xc480c48,0xc48,0x13148,0x1a420
.long 0xc440c44,0xc44,0x14188,0x1a440,0xc400c40,0xc40,0x151c8,0x1a460
.long 0xc3c0c3c,0xc3c,0x12100,0x1a480,0xc380c38,0xc38,0x13140,0x1a4a0
.long 0xc340c34,0xc34,0x14180,0x1a4c0,0xc300c30,0xc30,0x151c0,0x1a4e0
.long 0xc1c0c1c,0xc1c,0x12128,0x1a310,0xc180c18,0xc18,0x13168,0x1a330
.long 0xc140c14,0xc14,0x141a8,0x1a350,0xc100c10,0xc10,0x151e8,0x1a370
.long 0xc0c0c0c,0xc0c,0x12120,0x1a390,0xc080c08,0xc08,0x13160,0x1a3b0
.long 0xc040c04,0xc04,0x141a0,0x1a3d0,0xc000c00,0xc00,0x151e0,0x1a3f0
.long 0xbfc0bfc,0xbfc,0x12118,0x1a410,0xbf80bf8,0xbf8,0x13158,0x1a430
.long 0xbf40bf4,0xbf4,0x14198,0x1a450,0xbf00bf0,0xbf0,0x151d8,0x1a470
.long 0xbec0bec,0xbec,0x12110,0x1a490,0xbe80be8,0xbe8,0x13150,0x1a4b0
.long 0xbe40be4,0xbe4,0x14190,0x1a4d0,0xbe00be0,0xbe0,0x151d0,0x1a4f0
.long 0xbcc0bcc,0xbcc,0x12138,0x1a320,0xbc80bc8,0xbc8,0x13178,0x1a340
.long 0xbc40bc4,0xbc4,0x141b8,0x1a360,0xbc00bc0,0xbc0,0x151f8,0x1a380
.long 0xbbc0bbc,0xbbc,0x12130,0x1a3a0,0xbb80bb8,0xbb8,0x13170,0x1a3c0
.long 0xbb40bb4,0xbb4,0x141b0,0x1a3e0,0xbb00bb0,0xbb0,0x151f0,0x1a400
.long 0xbac0bac,0xbac,0x12128,0x1a420,0xba80ba8,0xba8,0x13168,0x1a440
.long 0xba40ba4,0xba4,0x141a8,0x1a460,0xba00ba0,0xba0,0x151e8,0x1a480
.long 0xb9c0b9c,0xb9c,0x12120,0x1a4a0,0xb980b98,0xb98,0x13160,0x1a4c0
.long 0xb940b94,0xb94,0x141a0,0x1a4e0,0xb900b90,0xb90,0x151e0,0x1a500
.long 0xb7c0b7c,0xb7c,0x12148,0x1a330,0xb780b78,0xb78,0x13188,0x1a350
.long 0xb740b74,0xb74,0x141c8,0x1a370,0xb700b70,0xb70,0x15208,0x1a390
.long 0xb6c0b6c,0xb6c,0x12140,0x1a3b0,0xb680b68,0xb68,0x13180,0x1a3d0
.long 0xb640b64,0xb64,0x141c0,0x1a3f0,0xb600b60,0xb60,0x15200,0x1a410
.long 0xb5c0b5c,0xb5c,0x12138,0x1a430,0xb580b58,0xb58,0x13178,0x1a450
.long 0xb540b54,0xb54,0x141b8,0x1a470,0xb500b50,0xb50,0x151f8,0x1a490
.long 0xb4c0b4c,0xb4c,0x12130,0x1a4b0,0xb480b48,0xb48,0x13170,0x1a4d0
.long 0xb440b44,0xb44,0x141b0,0x1a4f0,0xb400b40,0xb40,0x151f0,0x1a510
.long 0xb2c0b2c,0xb2c,0x12018,0x1a200,0xb280b28,0xb28,0x13058,0x1a220
.long 0xb240b24,0xb24,0x14098,0x1a240,0xb200b20,0xb20,0x150d8,0x1a260
.long 0xb1c0b1c,0xb1c,0x12010,0x1a280,0xb180b18,0xb18,0x13050,0x1a2a0
.long 0xb140b14,0xb14,0x14090,0x1a2c0,0xb100b10,0xb10,0x150d0,0x1a2e0
.long 0xb0c0b0c,0xb0c,0x12008,0x1a300,0xb080b08,0xb08,0x13048,0x1a320
.long 0xb040b04,0xb04,0x14088,0x1a340,0xb000b00,0xb00,0x150c8,0x1a360
.long 0xafc0afc,0xafc,0x12000,0x1a380,0xaf80af8,0xaf8,0x13040,0x1a3a0
.long 0xaf40af4,0xaf4,0x14080,0x1a3c0,0xaf00af0,0xaf0,0x150c0,0x1a3e0
.long 0xadc0adc,0xadc,0x12028,0x1a210,0xad80ad8,0xad8,0x13068,0x1a230
.long 0xad40ad4,0xad4,0x140a8,0x1a250,0xad00ad0,0xad0,0x150e8,0x1a270
.long 0xacc0acc,0xacc,0x12020,0x1a290,0xac80ac8,0xac8,0x13060,0x1a2b0
.long 0xac40ac4,0xac4,0x140a0,0x1a2d0,0xac00ac0,0xac0,0x150e0,0x1a2f0
.long 0xabc0abc,0xabc,0x12018,0x1a310,0xab80ab8,0xab8,0x13058,0x1a330
.long 0xab40ab4,0xab4,0x14098,0x1a350,0xab00ab0,0xab0,0x150d8,0x1a370
.long 0xaac0aac,0xaac,0x12010,0x1a390,0xaa80aa8,0xaa8,0x13050,0x1a3b0
.long 0xaa40aa4,0xaa4,0x14090,0x1a3d0,0xaa00aa0,0xaa0,0x150d0,0x1a3f0
.long 0xa8c0a8c,0xa8c,0x12038,0x1a220,0xa880a88,0xa88,0x13078,0x1a240
.long 0xa840a84,0xa84,0x140b8,0x1a260,0xa800a80,0xa80,0x150f8,0x1a280
.long 0xa7c0a7c,0xa7c,0x12030,0x1a2a0,0xa780a78,0xa78,0x13070,0x1a2c0
.long 0xa740a74,0xa74,0x140b0,0x1a2e0,0xa700a70,0xa70,0x150f0,0x1a300
.long 0xa6c0a6c,0xa6c,0x12028,0x1a320,0xa680a68,0xa68,0x13068,0x1a340
.long 0xa640a64,0xa64,0x140a8,0x1a360,0xa600a60,0xa60,0x150e8,0x1a380
.long 0xa5c0a5c,0xa5c,0x12020,0x1a3a0,0xa580a58,0xa58,0x13060,0x1a3c0
.long 0xa540a54,0xa54,0x140a0,0x1a3e0,0xa500a50,0xa50,0x150e0,0x1a400
.long 0xa3c0a3c,0xa3c,0x12048,0x1a230,0xa380a38,0xa38,0x13088,0x1a250
.long 0xa340a34,0xa34,0x140c8,0x1a270,0xa300a30,0xa30,0x15108,0x1a290
.long 0xa2c0a2c,0xa2c,0x12040,0x1a2b0,0xa280a28,0xa28,0x13080,0x1a2d0
.long 0xa240a24,0xa24,0x140c0,0x1a2f0,0xa200a20,0xa20,0x15100,0x1a310
.long 0xa1c0a1c,0xa1c,0x12038,0x1a330,0xa180a18,0xa18,0x13078,0x1a350
.long 0xa140a14,0xa14,0x140b8,0x1a370,0xa100a10,0xa10,0x150f8,0x1a390
.long 0xa0c0a0c,0xa0c,0x12030,0x1a3b0,0xa080a08,0xa08,0x13070,0x1a3d0
.long 0xa040a04,0xa04,0x140b0,0x1a3f0,0xa000a00,0x9ec,0x150f0,0x1a410
.long 0x99c099c,0x9e8,0x16218,0x1b500,0x9980998,0x9e4,0x17258,0x1b520
.long 0x9940994,0x9e0,0x18298,0x1b540,0x9900990,0x9dc,0x192d8,0x1b560
.long 0x98c098c,0x9d8,0x16210,0x1b580,0x9880988,0x9d4,0x17250,0x1b5a0
.long 0x9840984,0x9d0,0x18290,0x1b5c0,0x9800980,0x9cc,0x192d0,0x1b5e0
.long 0x97c097c,0x9c8,0x16208,0x1b600,0x9780978,0x9c4,0x17248,0x1b620
.long 0x9740974,0x9c0,0x18288,0x1b640,0x9700970,0x9bc,0x192c8,0x1b660
.long 0x96c096c,0x9b8,0x16200,0x1b680,0x9680968,0x9b4,0x17240,0x1b6a0
.long 0x9640964,0x9b0,0x18280,0x1b6c0,0x9600960,0x94c,0x192c0,0x1b6e0
.long 0x8fc08fc,0x948,0x16228,0x1b510,0x8f808f8,0x944,0x17268,0x1b530
.long 0x8f408f4,0x940,0x182a8,0x1b550,0x8f008f0,0x93c,0x192e8,0x1b570
.long 0x8ec08ec,0x938,0x16220,0x1b590,0x8e808e8,0x934,0x17260,0x1b5b0
.long 0x8e408e4,0x930,0x182a0,0x1b5d0,0x8e008e0,0x92c,0x192e0,0x1b5f0
.long 0x8dc08dc,0x928,0x16218,0x1b610,0x8d808d8,0x924,0x17258,0x1b630
.long 0x8d408d4,0x920,0x18298,0x1b650,0x8d008d0,0x91c,0x192d8,0x1b670
.long 0x8cc08cc,0x918,0x16210,0x1b690,0x8c808c8,0x914,0x17250,0x1b6b0
.long 0x8c408c4,0x910,0x18290,0x1b6d0,0x8c008c0,0x8ac,0x192d0,0x1b6f0
.long 0x85c085c,0x8a8,0x16238,0x1b520,0x8580858,0x8a4,0x17278,0x1b540
.long 0x8540854,0x8a0,0x182b8,0x1b560,0x8500850,0x89c,0x192f8,0x1b580
.long 0x84c084c,0x898,0x16230,0x1b5a0,0x8480848,0x894,0x17270,0x1b5c0
.long 0x8440844,0x890,0x182b0,0x1b5e0,0x8400840,0x88c,0x192f0,0x1b600
.long 0x83c083c,0x888,0x16228,0x1b620,0x8380838,0x884,0x17268,0x1b640
.long 0x8340834,0x880,0x182a8,0x1b660,0x8300830,0x87c,0x192e8,0x1b680
.long 0x82c082c,0x878,0x16220,0x1b6a0,0x8280828,0x874,0x17260,0x1b6c0
.long 0x8240824,0x870,0x182a0,0x1b6e0,0x8200820,0x80c,0x192e0,0x1b700
.long 0x7bc07bc,0x808,0x16248,0x1b530,0x7b807b8,0x804,0x17288,0x1b550
.long 0x7b407b4,0x800,0x182c8,0x1b570,0x7b007b0,0x7fc,0x19308,0x1b590
.long 0x7ac07ac,0x7f8,0x16240,0x1b5b0,0x7a807a8,0x7f4,0x17280,0x1b5d0
.long 0x7a407a4,0x7f0,0x182c0,0x1b5f0,0x7a007a0,0x7ec,0x19300,0x1b610
.long 0x79c079c,0x7e8,0x16238,0x1b630,0x7980798,0x7e4,0x17278,0x1b650
.long 0x7940794,0x7e0,0x182b8,0x1b670,0x7900790,0x7dc,0x192f8,0x1b690
.long 0x78c078c,0x7d8,0x16230,0x1b6b0,0x7880788,0x7d4,0x17270,0x1b6d0
.long 0x7840784,0x7d0,0x182b0,0x1b6f0,0x76c0780,0x71c,0x192f0,0x1b710
.long 0x768067c,0x718,0x16118,0x1b400,0x7640678,0x714,0x17158,0x1b420
.long 0x7600674,0x710,0x18198,0x1b440,0x75c0670,0x70c,0x191d8,0x1b460
.long 0x758066c,0x708,0x16110,0x1b480,0x7540668,0x704,0x17150,0x1b4a0
.long 0x7500664,0x700,0x18190,0x1b4c0,0x74c0660,0x6fc,0x191d0,0x1b4e0
.long 0x748065c,0x6f8,0x16108,0x1b500,0x7440658,0x6f4,0x17148,0x1b520
.long 0x7400654,0x6f0,0x18188,0x1b540,0x73c0650,0x6ec,0x191c8,0x1b560
.long 0x738064c,0x6e8,0x16100,0x1b580,0x7340648,0x6e4,0x17140,0x1b5a0
.long 0x7300644,0x6e0,0x18180,0x1b5c0,0x62c0640,0x5dc,0x191c0,0x1b5e0
.long 0x628053c,0x5d8,0x16128,0x1b410,0x6240538,0x5d4,0x17168,0x1b430
.long 0x6200534,0x5d0,0x181a8,0x1b450,0x61c0530,0x5cc,0x191e8,0x1b470
.long 0x618052c,0x5c8,0x16120,0x1b490,0x6140528,0x5c4,0x17160,0x1b4b0
.long 0x6100524,0x5c0,0x181a0,0x1b4d0,0x60c0520,0x5bc,0x191e0,0x1b4f0
.long 0x608051c,0x5b8,0x16118,0x1b510,0x6040518,0x5b4,0x17158,0x1b530
.long 0x6000514,0x5b0,0x18198,0x1b550,0x5fc0510,0x5ac,0x191d8,0x1b570
.long 0x5f8050c,0x5a8,0x16110,0x1b590,0x5f40508,0x5a4,0x17150,0x1b5b0
.long 0x5f00504,0x5a0,0x18190,0x1b5d0,0x49c04ec,0x44c,0x191d0,0x1b5f0
.long 0x49804e8,0x448,0x16138,0x1b420,0x49404e4,0x444,0x17178,0x1b440
.long 0x49004e0,0x440,0x181b8,0x1b460,0x48c04dc,0x43c,0x191f8,0x1b480
.long 0x48804d8,0x438,0x16130,0x1b4a0,0x48404d4,0x434,0x17170,0x1b4c0
.long 0x48004d0,0x430,0x181b0,0x1b4e0,0x47c04cc,0x42c,0x191f0,0x1b500
.long 0x47804c8,0x428,0x16128,0x1b520,0x47404c4,0x424,0x17168,0x1b540
.long 0x47004c0,0x420,0x181a8,0x1b560,0x46c04bc,0x41c,0x191e8,0x1b580
.long 0x46804b8,0x418,0x16120,0x1b5a0,0x46404b4,0x414,0x17160,0x1b5c0
.long 0x46004b0,0x410,0x181a0,0x1b5e0,0x21c026c,0x1cc,0x191e0,0x1b600
.long 0x2180268,0x1c8,0x16148,0x1b430,0x2140264,0x1c4,0x17188,0x1b450
.long 0x2100260,0x1c0,0x181c8,0x1b470,0x20c025c,0x1bc,0x19208,0x1b490
.long 0x2080258,0x1b8,0x16140,0x1b4b0,0x2040254,0x1b4,0x17180,0x1b4d0
.long 0x2000250,0x1b0,0x181c0,0x1b4f0,0x1fc024c,0x1ac,0x19200,0x1b510
.long 0x1f80248,0x1a8,0x16138,0x1b530,0x1f40244,0x1a4,0x17178,0x1b550
.long 0x1f00240,0x1a0,0x181b8,0x1b570,0x1ec023c,0x19c,0x191f8,0x1b590
.long 0x1e80238,0x198,0x16130,0x1b5b0,0x1e40234,0x194,0x17170,0x1b5d0
.long 0x1e00230,0x190,0x181b0,0x1b5f0,0xf000f00,0xf00,0x191f0,0x1b610
.fill 0, 4, 0
.size L_table, 8192
.section .rodata,"a"
.p2align 6
.amdhsa_kernel adaLN_cond__ssm_conv_s4__geglu_ffn__prompt_kernel
  .amdhsa_next_free_vgpr 512
  .amdhsa_next_free_sgpr 102
  .amdhsa_accum_offset 256
  .amdhsa_group_segment_fixed_size 0
  .amdhsa_kernarg_size 144
  .amdhsa_user_sgpr_count 2
  .amdhsa_user_sgpr_kernarg_segment_ptr 1
  .amdhsa_system_sgpr_workgroup_id_x 1
  .amdhsa_float_denorm_mode_32 3
.end_amdhsa_kernel
```
